```python
import torch

def _softmax(x, axis=-1):
    return torch.softmax(x, dim=axis)

def _gelu(x):
    return torch.nn.functional.gelu(x, approximate='tanh')

def _silu(x):
    return torch.nn.functional.silu(x)

def _sigmoid(x):
    return torch.sigmoid(x)

def _layernorm(x, axis=-1, eps=1e-05):
    m = x.mean(dim=axis, keepdim=True)
    v = x.var(dim=axis, keepdim=True, unbiased=False)
    return (x - m) / torch.sqrt(v + eps)

def _scatter_add(tgt, idx, src, axis=0):
    return tgt.clone().index_add_(axis, idx, src)

def _segment_sum(src, seg, n):
    out = torch.zeros((n,) + src.shape[1:], dtype=src.dtype)
    return out.index_add_(0, seg, src)

def _pad(x, pw):
    flat = tuple((v for pair in reversed(pw) for v in pair))
    return torch.nn.functional.pad(x, flat)
kernel_name = 'recurrent_scan__memory_aug_recurrent_mem_tr__glu_gated_bilinear__prompt'

def setup_inputs():

    _w = lambda a: (lambda t: t.to(torch.bfloat16) if t.is_floating_point() else t)(torch.as_tensor(a))

    def _A_setup():
        B, S, Dm = (1, 2048, 512)
        H, Dh = (32, 128)
        M, seg = (8, 32)
        seg = min(seg, S)
        S = S // seg * seg
        return {'x': _w((lambda *s: torch.randn(*s, dtype=torch.bfloat16) * 0.1)(B, S, Dm)), 'mem0': _w((lambda *s: torch.randn(*s, dtype=torch.bfloat16) * 1.6)(B, M, Dm)), 'Wq': _w((lambda *s: torch.randn(*s, dtype=torch.bfloat16) * 0.8)(Dm, H, Dh) * Dm ** (-0.5)), 'Wk': _w((lambda *s: torch.randn(*s, dtype=torch.bfloat16) * 0.8)(Dm, H, Dh) * Dm ** (-0.5)), 'Wv': _w((lambda *s: torch.randn(*s, dtype=torch.bfloat16) * 1.6)(Dm, H, Dh) * Dm ** (-0.5)), 'Wo': _w((lambda *s: torch.randn(*s, dtype=torch.bfloat16) * 1.6)(H, Dh, Dm) * (H * Dh) ** (-0.5)), 'seg_len': seg}
    _A_in = _A_setup()

    def _B_setup():
        B, S, D, F = (1, 2048, 512, 1376)
        return {'x': _w((lambda *s: torch.randn(*s, dtype=torch.bfloat16) * 0.1)(B, S, D)), 'w_gate': _w((lambda *s: torch.randn(*s, dtype=torch.bfloat16) * 0.4)(D, F) * D ** (-0.5)), 'w_up': _w((lambda *s: torch.randn(*s, dtype=torch.bfloat16) * 0.4)(D, F) * D ** (-0.5)), 'w_down': _w((lambda *s: torch.randn(*s, dtype=torch.bfloat16) * 0.4)(F, D) * F ** (-0.5))}
    _B_in = _B_setup()
    return {'A_x': _A_in['x'], 'A_mem0': _A_in['mem0'], 'A_Wq': _A_in['Wq'], 'A_Wk': _A_in['Wk'], 'A_Wv': _A_in['Wv'], 'A_Wo': _A_in['Wo'], 'A_seg_len': _A_in['seg_len'], 'B_x': _B_in['x'], 'B_w_gate': _B_in['w_gate'], 'B_w_up': _B_in['w_up'], 'B_w_down': _B_in['w_down']}

def reference(A_x, A_mem0, A_Wq, A_Wk, A_Wv, A_Wo, A_seg_len, B_x, B_w_gate, B_w_up, B_w_down):

    def _A_ref(x, mem0, Wq, Wk, Wv, Wo, seg_len):
        B, S, Dm = x.shape
        H, Dh = (Wq.shape[1], Wq.shape[2])
        M = mem0.shape[1]
        scale = Dh ** (-0.5)
        n_seg = S // seg_len
        L = M + seg_len
        idx = torch.arange(L)
        mask = (idx[:, None] < M) | (idx[:, None] >= idx[None, :])
        mem = mem0
        outs = []
        for s in range(n_seg):
            xs = x[:, s * seg_len:(s + 1) * seg_len, :].clone()
            h = torch.concatenate([mem, xs], axis=1)
            q = torch.einsum('btd,dhe->bhte', h, Wq)
            k = torch.einsum('btd,dhe->bhte', h, Wk)
            v = torch.einsum('btd,dhe->bhte', h, Wv)
            scores = torch.einsum('bhqe,bhke->bhqk', q, k) * scale
            scores = torch.where(mask[None, None], scores, -1000000000.0)
            p = _softmax(scores, axis=-1)
            o = torch.einsum('bhqk,bhke->bhqe', p, v)
            o = torch.einsum('bhte,hed->btd', o, Wo)
            mem = o[:, :M, :].clone()
            outs.append(o[:, M:, :])
        return torch.concatenate(outs, axis=1)

    def _B_ref(x, w_gate, w_up, w_down):
        g = torch.einsum('bsd,df->bsf', x, w_gate)
        u = torch.einsum('bsd,df->bsf', x, w_up)
        h = g * u
        return torch.einsum('bsf,fd->bsd', h, w_down)
    x = A_x
    xn = _layernorm(x, axis=-1)
    s = _A_ref(xn, A_mem0, A_Wq, A_Wk, A_Wv, A_Wo, A_seg_len)
    g = _silu(_B_ref(xn, B_w_gate, B_w_up, B_w_down))
    return x + s * g
```

```asm
; @launch grid=(256,1,1) block=(256,1,1) lds=163840
.amdgcn_target "amdgcn-amd-amdhsa--gfx950"
.text
.globl recurrent_scan__memory_aug_recurrent_mem_tr__glu_gated_bilinear__prompt_kernel
.p2align 8
.type recurrent_scan__memory_aug_recurrent_mem_tr__glu_gated_bilinear__prompt_kernel,@function
recurrent_scan__memory_aug_recurrent_mem_tr__glu_gated_bilinear__prompt_kernel:
    s_cmp_ge_u32 s2, 256
    s_cbranch_scc1 L_end
    s_load_dwordx2 s[12:13], s[0:1], 0
    s_load_dwordx2 s[16:17], s[0:1], 8
    s_load_dwordx2 s[20:21], s[0:1], 16
    s_load_dwordx2 s[24:25], s[0:1], 24
    s_load_dwordx2 s[28:29], s[0:1], 32
    s_load_dwordx2 s[32:33], s[0:1], 40
    s_load_dwordx2 s[36:37], s[0:1], 64
    s_load_dwordx2 s[40:41], s[0:1], 72
    s_load_dwordx2 s[44:45], s[0:1], 80
    s_load_dwordx2 s[48:49], s[0:1], 88
    s_load_dwordx2 s[8:9], s[0:1], 96
    s_load_dwordx2 s[4:5], s[0:1], 104
    s_mov_b32 s6, 0x10000000
    s_mov_b32 s7, 0x00020000
    s_mov_b32 s10, 0x100
    s_mov_b32 s11, 0x00020000
    s_mov_b32 s14, 0x200000
    s_mov_b32 s15, 0x00020000
    s_mov_b32 s18, 0x2000
    s_mov_b32 s19, 0x00020000
    s_mov_b32 s22, 0x400000
    s_mov_b32 s23, 0x00020000
    s_mov_b32 s26, 0x400000
    s_mov_b32 s27, 0x00020000
    s_mov_b32 s30, 0x400000
    s_mov_b32 s31, 0x00020000
    s_mov_b32 s34, 0x400000
    s_mov_b32 s35, 0x00020000
    s_mov_b32 s38, 0x158000
    s_mov_b32 s39, 0x00020000
    s_mov_b32 s42, 0x158000
    s_mov_b32 s43, 0x00020000
    s_mov_b32 s46, 0x158000
    s_mov_b32 s47, 0x00020000
    s_mov_b32 s50, 0x200000
    s_mov_b32 s51, 0x00020000
    v_lshrrev_b32 v1, 6, v0
    v_lshlrev_b32 v4, 4, v0
    v_and_b32 v0, 63, v0
    v_readfirstlane_b32 s52, v1
    s_getreg_b32 s54, hwreg(HW_REG_XCC_ID, 0, 4)
    s_mov_b32 s59, 0x10000
    v_mov_b32 v2, 0
    v_lshlrev_b32 v5, 2, v0
    s_min_u32 s54, s54, 8
    s_lshl_b32 s55, s54, 2
    s_lshr_b32 s55, 0x36210745, s55
    s_and_b32 s55, s55, 7
    s_cmp_lt_u32 s54, 8
    s_cselect_b32 s54, s55, s54
    s_cmp_lt_u32 s52, 2
    s_cbranch_scc1 L_nocw
    s_getpc_b64 s[60:61]
L_pc:
    s_lshr_b32 s55, s2, 3
    s_and_b32 s55, s55, 31
    s_lshl_b32 s55, s55, 11
    s_sub_u32 s55, s55, 2048
    v_add_u32 v6, s55, v4
    v_min_u32 v6, L_end-L_pc-16, v6
    v_mov_b32 v7, s61
    v_add_co_u32 v6, vcc, s60, v6
    s_nop 1
    v_addc_co_u32 v7, vcc, 0, v7, vcc
    global_load_dwordx4 a[252:255], v[6:7], off
L_nocw:
    s_waitcnt lgkmcnt(0)
    s_cmp_lg_u32 s52, 1
    s_cbranch_scc1 L_notw
    s_lshr_b32 s55, s2, 3
    s_and_b32 s55, s55, 31
    s_mul_i32 s55, s55, 3145728
    v_min_u32 v6, 2, v0
    v_lshlrev_b32 v6, 20, v6
    buffer_load_dword a251, v6, s[4:7], s55 offen offset:4032
L_notw:
    s_cmp_lg_u32 s52, 0
    s_cbranch_scc1 L_ticket_wait
    s_lshl_b32 s56, s54, 1
    s_lshr_b32 s56, 0x37fa8, s56
    s_and_b32 s56, s56, 3
    s_lshl_b32 s56, s56, 4
    s_add_u32 s56, s56, s54
    s_lshl_b32 s56, s56, 2
    s_mov_b64 exec, 1
    v_mov_b32 v3, 1
    buffer_atomic_add v3, v2, s[8:11], s56 offen sc0 sc1
    s_waitcnt vmcnt(0)
    v_readfirstlane_b32 s55, v3
    s_mov_b64 exec, -1
    s_cmp_ge_u32 s54, 8
    s_cbranch_scc1 L_overflow
    s_cmp_ge_u32 s55, 32
    s_cbranch_scc1 L_overflow
    s_lshl_b32 s56, s54, 5
    s_add_u32 s55, s55, s56
    s_branch L_ticket_done
L_overflow:
    buffer_load_dword v3, v5, s[8:11], 0 offen sc1
    s_waitcnt vmcnt(0)
    v_readlane_b32 s60, v3, 0
    v_readlane_b32 s61, v3, 33
    v_readlane_b32 s62, v3, 34
    v_readlane_b32 s63, v3, 35
    v_readlane_b32 s64, v3, 52
    v_readlane_b32 s65, v3, 53
    v_readlane_b32 s66, v3, 54
    v_readlane_b32 s67, v3, 23
    v_readlane_b32 s68, v3, 56
    s_mov_b32 s55, s60
    s_add_u32 s55, s55, s61
    s_add_u32 s55, s55, s62
    s_add_u32 s55, s55, s63
    s_add_u32 s55, s55, s64
    s_add_u32 s55, s55, s65
    s_add_u32 s55, s55, s66
    s_add_u32 s55, s55, s67
    s_add_u32 s55, s55, s68
    s_cmp_ge_u32 s55, 256
    s_cbranch_scc1 L_ovf_all
    s_sub_u32 s59, s59, 1
    s_cbranch_scc1 L_noslot
    s_sleep 8
    s_branch L_overflow
L_ovf_all:
    s_mov_b64 exec, 1
    v_mov_b32 v3, 1
    buffer_atomic_add v3, v2, s[8:11], 0 offen offset:4 sc0 sc1
    s_waitcnt vmcnt(0)
    v_readfirstlane_b32 s56, v3
    s_mov_b64 exec, -1
    s_min_u32 s57, s60, 32
    s_add_u32 s55, s57, s56
    s_cmp_lt_u32 s55, 32
    s_cbranch_scc1 L_ovf_0
    s_sub_u32 s56, s55, 32
    s_min_u32 s57, s61, 32
    s_add_u32 s55, s57, s56
    s_cmp_lt_u32 s55, 32
    s_cbranch_scc1 L_ovf_1
    s_sub_u32 s56, s55, 32
    s_min_u32 s57, s62, 32
    s_add_u32 s55, s57, s56
    s_cmp_lt_u32 s55, 32
    s_cbranch_scc1 L_ovf_2
    s_sub_u32 s56, s55, 32
    s_min_u32 s57, s63, 32
    s_add_u32 s55, s57, s56
    s_cmp_lt_u32 s55, 32
    s_cbranch_scc1 L_ovf_3
    s_sub_u32 s56, s55, 32
    s_min_u32 s57, s64, 32
    s_add_u32 s55, s57, s56
    s_cmp_lt_u32 s55, 32
    s_cbranch_scc1 L_ovf_4
    s_sub_u32 s56, s55, 32
    s_min_u32 s57, s65, 32
    s_add_u32 s55, s57, s56
    s_cmp_lt_u32 s55, 32
    s_cbranch_scc1 L_ovf_5
    s_sub_u32 s56, s55, 32
    s_min_u32 s57, s66, 32
    s_add_u32 s55, s57, s56
    s_cmp_lt_u32 s55, 32
    s_cbranch_scc1 L_ovf_6
    s_sub_u32 s56, s55, 32
    s_min_u32 s57, s67, 32
    s_add_u32 s55, s57, s56
    s_cmp_lt_u32 s55, 32
    s_cbranch_scc1 L_ovf_7
    s_sub_u32 s56, s55, 32
L_noslot:
    s_mov_b32 s55, 0x10000
    s_branch L_ticket_done
L_ovf_7:
    s_add_u32 s55, s55, 224
    s_branch L_ticket_done
L_ovf_6:
    s_add_u32 s55, s55, 192
    s_branch L_ticket_done
L_ovf_5:
    s_add_u32 s55, s55, 160
    s_branch L_ticket_done
L_ovf_4:
    s_add_u32 s55, s55, 128
    s_branch L_ticket_done
L_ovf_3:
    s_add_u32 s55, s55, 96
    s_branch L_ticket_done
L_ovf_2:
    s_add_u32 s55, s55, 64
    s_branch L_ticket_done
L_ovf_1:
    s_add_u32 s55, s55, 32
    s_branch L_ticket_done
L_ovf_0:
    s_mov_b64 exec, 1
    v_mov_b32 v3, 1
    buffer_atomic_add v3, v2, s[8:11], 0 offen offset:12 sc0 sc1
    s_waitcnt vmcnt(0)
    s_mov_b64 exec, -1
L_ticket_done:
    v_mov_b32 v3, s55
    ds_write_b32 v2, v3
    s_waitcnt lgkmcnt(0)
L_ticket_wait:
    s_barrier
    ds_read_b32 v3, v2
    s_waitcnt lgkmcnt(0)
    v_readfirstlane_b32 s53, v3
    s_barrier
    s_cmp_lt_u32 s53, 32
    s_cbranch_scc1 L_head
    s_cmp_lt_u32 s53, 128
    s_cbranch_scc1 L_qkv
    s_cmp_lt_u32 s53, 216
    s_cbranch_scc1 L_glu
    s_cmp_lt_u32 s53, 224
    s_cbranch_scc1 L_fin
    s_cmp_ge_u32 s53, 256
    s_cbranch_scc1 L_end
    s_cmp_lg_u32 s53, 224
    s_cbranch_scc1 L_ln
    v_mov_b64 v[8:9], 0
    v_mov_b64 v[10:11], 0
    s_mov_b32 s57, 0
    buffer_store_dwordx4 v[8:11], v4, s[4:7], s57 offen sc1
    s_add_u32 s57, s57, 0x1000
    buffer_store_dwordx4 v[8:11], v4, s[4:7], s57 offen sc1
    s_add_u32 s57, s57, 0x1000
    buffer_store_dwordx4 v[8:11], v4, s[4:7], s57 offen sc1
    s_add_u32 s57, s57, 0x1000
    buffer_store_dwordx4 v[8:11], v4, s[4:7], s57 offen sc1
    s_add_u32 s57, s57, 0x1000
    buffer_store_dwordx4 v[8:11], v4, s[4:7], s57 offen sc1
    s_add_u32 s57, s57, 0x1000
    s_waitcnt vmcnt(0)
    s_barrier
    s_cmp_lg_u32 s52, 0
    s_cbranch_scc1 L_ln
    v_mov_b32 v3, 1
    s_mov_b64 exec, 1
    buffer_store_dword v3, v2, s[8:11], 0 offen offset:16 sc1
    s_mov_b64 exec, -1
    s_branch L_ln
L_head:
    v_mov_b32 v23, v0
    v_lshrrev_b32 v18, 4, v23
    v_and_b32 v19, 15, v23
    s_lshr_b32 s55, s53, 3
    s_lshl_b32 s55, s55, 4
    s_and_b32 s56, s53, 7
    s_add_u32 s55, s55, s56
    s_lshl_b32 s56, s52, 3
    s_add_u32 s55, s55, s56
    s_add_u32 s55, s55, 48
    s_lshl_b32 s56, s53, 1
    s_add_u32 s56, s56, s52
    s_cmp_lt_u32 s52, 2
    s_cselect_b32 s12, s56, s55
    s_cselect_b32 s57, 64, 2
    s_cselect_b32 s58, 2, 4
    v_lshrrev_b32 v21, 1, v18
    v_lshlrev_b32 v21, 10, v21
    v_and_b32 v22, 1, v18
    v_mad_u32_u24 v21, v22, s57, v21
    v_and_b32 v22, 3, v19
    v_mad_u32_u24 v21, v22, s58, v21
    s_and_b32 s57, s12, 12
    s_lshl_b32 s55, s57, 1
    s_and_b32 s56, s12, 8
    s_lshl_b32 s56, s56, 3
    s_and_b32 s57, s12, 4
    s_lshl_b32 s57, s57, 2
    s_add_u32 s56, s56, s57
    s_add_u32 s56, s56, 128
    s_cmp_lt_u32 s52, 2
    s_cselect_b32 s55, s55, s56
    s_lshr_b32 s56, s53, 3
    s_lshl_b32 s56, s56, 8
    s_add_u32 s55, s55, s56
    s_and_b32 s56, s12, 3
    s_lshl_b32 s56, s56, 11
    s_add_u32 s55, s55, s56
    buffer_load_ushort v126, v21, s[16:19], s55 offen
    buffer_load_ushort v127, v21, s[16:19], s55 offen offset:32
    v_lshlrev_b32 v21, 1, v18
    v_xor_b32 v21, v21, v19
    v_lshlrev_b32 v116, 4, v21
    v_xor_b32 v117, 128, v116
    v_lshrrev_b32 v21, 2, v19
    v_and_b32 v22, 1, v18
    v_lshl_add_u32 v22, v22, 2, v21
    v_lshlrev_b32 v22, 5, v22
    v_lshl_add_u32 v21, v18, 3, v21
    v_lshlrev_b32 v21, 8, v21
    v_and_b32 v118, 3, v19
    v_lshlrev_b32 v118, 3, v118
    s_lshl_b32 s55, s52, 6
    v_add_u32 v118, s55, v118
    v_xor_b32 v118, v118, v22
    v_add_u32 v118, v118, v21
    v_xor_b32 v119, 32, v118
    s_lshl_b32 s58, s52, 15
    v_lshl_add_u32 v114, v18, 17, v116
    v_lshl_add_u32 v115, v18, 17, v117
    v_and_b32 v21, 1, v18
    v_lshlrev_b32 v21, 4, v21
    v_lshrrev_b32 v22, 1, v18
    v_add_u32 v21, v21, v22
    v_lshl_add_u32 v16, v21, 13, v116
    v_lshl_add_u32 v17, v21, 13, v117
    s_lshl_b32 s55, s52, 20
    s_lshl_b32 s56, s53, 8
    s_add_u32 s80, s55, s56
    s_add_u32 m0, s58, 0
    s_add_u32 s55, s80, 0
    buffer_load_dwordx4 v114, s[20:23], s55 offen nt lds
    s_add_u32 m0, s58, 1024
    s_add_u32 s55, s80, 8192
    buffer_load_dwordx4 v114, s[20:23], s55 offen nt lds
    s_add_u32 m0, s58, 2048
    s_add_u32 s55, s80, 16384
    buffer_load_dwordx4 v115, s[20:23], s55 offen nt lds
    s_add_u32 m0, s58, 3072
    s_add_u32 s55, s80, 24576
    buffer_load_dwordx4 v115, s[20:23], s55 offen nt lds
    s_add_u32 m0, s58, 4096
    s_add_u32 s55, s80, 32768
    buffer_load_dwordx4 v114, s[20:23], s55 offen nt lds
    s_add_u32 m0, s58, 5120
    s_add_u32 s55, s80, 40960
    buffer_load_dwordx4 v114, s[20:23], s55 offen nt lds
    s_add_u32 m0, s58, 6144
    s_add_u32 s55, s80, 49152
    buffer_load_dwordx4 v115, s[20:23], s55 offen nt lds
    s_add_u32 m0, s58, 7168
    s_add_u32 s55, s80, 57344
    buffer_load_dwordx4 v115, s[20:23], s55 offen nt lds
    s_add_u32 m0, s58, 8192
    s_add_u32 s55, s80, 65536
    buffer_load_dwordx4 v114, s[20:23], s55 offen nt lds
    s_add_u32 m0, s58, 9216
    s_add_u32 s55, s80, 73728
    buffer_load_dwordx4 v114, s[20:23], s55 offen nt lds
    s_add_u32 m0, s58, 10240
    s_add_u32 s55, s80, 81920
    buffer_load_dwordx4 v115, s[20:23], s55 offen nt lds
    s_add_u32 m0, s58, 11264
    s_add_u32 s55, s80, 90112
    buffer_load_dwordx4 v115, s[20:23], s55 offen nt lds
    s_add_u32 m0, s58, 12288
    s_add_u32 s55, s80, 98304
    buffer_load_dwordx4 v114, s[20:23], s55 offen nt lds
    s_add_u32 m0, s58, 13312
    s_add_u32 s55, s80, 106496
    buffer_load_dwordx4 v114, s[20:23], s55 offen nt lds
    s_add_u32 m0, s58, 14336
    s_add_u32 s55, s80, 114688
    buffer_load_dwordx4 v115, s[20:23], s55 offen nt lds
    s_add_u32 m0, s58, 15360
    s_add_u32 s55, s80, 122880
    buffer_load_dwordx4 v115, s[20:23], s55 offen nt lds
    v_lshrrev_b32 v21, 1, v18
    v_lshlrev_b32 v21, 4, v21
    v_and_b32 v22, 1, v18
    v_add_u32 v21, v21, v22
    v_lshl_add_u32 v116, v21, 10, v116
    v_lshl_add_u32 v117, v21, 10, v117
    s_lshl_b32 s55, s53, 17
    s_lshl_b32 s56, s52, 8
    s_add_u32 s81, s55, s56
    s_add_u32 m0, s58, 16384
    s_add_u32 s55, s80, 524288
    buffer_load_dwordx4 v16, s[20:23], s55 offen nt lds
    s_add_u32 m0, s58, 17408
    s_add_u32 s55, s80, 540672
    buffer_load_dwordx4 v16, s[20:23], s55 offen nt lds
    s_add_u32 m0, s58, 18432
    s_add_u32 s55, s80, 557056
    buffer_load_dwordx4 v17, s[20:23], s55 offen nt lds
    s_add_u32 m0, s58, 19456
    s_add_u32 s55, s80, 573440
    buffer_load_dwordx4 v17, s[20:23], s55 offen nt lds
    s_add_u32 m0, s58, 20480
    s_add_u32 s55, s80, 589824
    buffer_load_dwordx4 v16, s[20:23], s55 offen nt lds
    s_add_u32 m0, s58, 21504
    s_add_u32 s55, s80, 606208
    buffer_load_dwordx4 v16, s[20:23], s55 offen nt lds
    s_add_u32 m0, s58, 22528
    s_add_u32 s55, s80, 622592
    buffer_load_dwordx4 v17, s[20:23], s55 offen nt lds
    s_add_u32 m0, s58, 23552
    s_add_u32 s55, s80, 638976
    buffer_load_dwordx4 v17, s[20:23], s55 offen nt lds
    s_add_u32 m0, s58, 24576
    s_add_u32 s55, s80, 786432
    buffer_load_dwordx4 v16, s[20:23], s55 offen nt lds
    s_add_u32 m0, s58, 25600
    s_add_u32 s55, s80, 802816
    buffer_load_dwordx4 v16, s[20:23], s55 offen nt lds
    s_add_u32 m0, s58, 26624
    s_add_u32 s55, s80, 819200
    buffer_load_dwordx4 v17, s[20:23], s55 offen nt lds
    s_add_u32 m0, s58, 27648
    s_add_u32 s55, s80, 835584
    buffer_load_dwordx4 v17, s[20:23], s55 offen nt lds
    s_add_u32 m0, s58, 28672
    s_add_u32 s55, s80, 851968
    buffer_load_dwordx4 v16, s[20:23], s55 offen nt lds
    s_add_u32 m0, s58, 29696
    s_add_u32 s55, s80, 868352
    buffer_load_dwordx4 v16, s[20:23], s55 offen nt lds
    s_add_u32 m0, s58, 30720
    s_add_u32 s55, s80, 884736
    buffer_load_dwordx4 v17, s[20:23], s55 offen nt lds
    s_add_u32 m0, s58, 31744
    s_add_u32 s55, s80, 901120
    buffer_load_dwordx4 v17, s[20:23], s55 offen nt lds
    s_add_u32 s55, s52, 3
    s_and_b32 s55, s55, 3
    s_lshl_b32 s55, s55, 15
    v_add_u32 v125, s55, v119
    v_add_u32 v124, s55, v118
    s_add_u32 s55, s52, 2
    s_and_b32 s55, s55, 3
    s_lshl_b32 s55, s55, 15
    v_add_u32 v123, s55, v119
    v_add_u32 v122, s55, v118
    s_add_u32 s55, s52, 1
    s_and_b32 s55, s55, 3
    s_lshl_b32 s55, s55, 15
    v_add_u32 v121, s55, v119
    v_add_u32 v120, s55, v118
    s_add_u32 s55, s52, 0
    s_and_b32 s55, s55, 3
    s_lshl_b32 s55, s55, 15
    v_add_u32 v119, s55, v119
    v_add_u32 v118, s55, v118
    v_lshlrev_b32 v1, 4, v23
    v_add_u32 v0, 131072, v1
    s_lshl_b32 s55, s52, 10
    v_add_u32 v10, s55, v1
    v_add_u32 v11, 131072, v10
    v_and_b32 v21, 62, v23
    v_lshlrev_b32 v21, 2, v21
    v_add_u32 v3, 131072, v21
    s_lshl_b32 s55, s52, 15
    v_add_u32 v15, s55, v1
    s_add_u32 s55, s52, 1
    s_and_b32 s55, s55, 3
    s_lshl_b32 s55, s55, 10
    v_add_u32 v12, s55, v0
    s_add_u32 s55, s52, 2
    s_and_b32 s55, s55, 3
    s_lshl_b32 s55, s55, 10
    v_add_u32 v13, s55, v0
    s_add_u32 s55, s52, 3
    s_and_b32 s55, s55, 3
    s_lshl_b32 s55, s55, 10
    v_add_u32 v14, s55, v0
    s_mov_b32 s72, 0xaaaaaaaa
    s_mov_b32 s73, 0xaaaaaaaa
    v_mov_b32 v21, 0x4444
    v_mov_b32 v22, 0xeeee
    v_cndmask_b32 v2, v21, v22, s[72:73]
    v_mov_b32 v21, 0x3f80
    v_mov_b32 v22, 0x3f800000
    v_cmp_le_u32 vcc, 8, v19
    s_nop 1
    v_cndmask_b32 v21, v21, v22, vcc
    v_bfe_u32 v22, v19, 2, 1
    v_and_b32 v20, 1, v19
    v_lshl_add_u32 v22, v22, 1, v20
    v_cmp_eq_u32 vcc, 0, v22
    s_nop 1
    v_cndmask_b32 v98, 0, v21, vcc
    v_cmp_eq_u32 vcc, 1, v22
    s_nop 1
    v_cndmask_b32 v99, 0, v21, vcc
    v_cmp_eq_u32 vcc, 2, v22
    s_nop 1
    v_cndmask_b32 v100, 0, v21, vcc
    v_cmp_eq_u32 vcc, 3, v22
    s_nop 1
    v_cndmask_b32 v101, 0, v21, vcc
    ds_write_b128 v0, v[98:101] offset:28928
    v_mov_b32 v102, 0x3f803f80
    v_mov_b32 v103, 0x3f803f80
    v_mov_b32 v104, 0x3f803f80
    v_mov_b32 v105, 0x3f803f80
    ds_write_b128 v0, v[102:105] offset:29952
    v_mov_b32 v106, 0
    v_mov_b32 v107, 0
    v_mov_b32 v108, 0
    v_mov_b32 v109, 0
    ds_write_b128 v0, v[106:109] offset:30976
    v_mul_u32_u24 v21, 1088, v18
    v_lshl_add_u32 v21, v19, 2, v21
    s_lshl_b32 s55, s52, 6
    s_add_u32 s56, s55, 155648
    v_add_u32 v4, s56, v21
    v_lshrrev_b32 v21, 1, v19
    v_mul_u32_u24 v21, 544, v21
    v_lshl_add_u32 v21, v18, 4, v21
    v_and_b32 v22, 1, v19
    v_lshl_add_u32 v21, v22, 7, v21
    v_add_u32 v5, 155648, v21
    v_lshlrev_b32 v21, 10, v22
    v_lshrrev_b32 v22, 1, v23
    v_lshl_add_u32 v22, v22, 4, v21
    s_lshl_b32 s56, s52, 10
    v_add_u32 v6, s56, v22
    s_and_b32 s56, s52, 1
    s_mul_i32 s56, s56, 2176
    s_cmp_lt_u32 s52, 2
    s_cselect_b32 s55, 256, 0
    s_cselect_b32 s14, 0, 1
    s_add_u32 s56, s56, s55
    s_add_u32 s13, s56, 24576
    s_mov_b32 s98, 0x55555555
    s_mov_b32 s99, 0x55555555
    v_and_b32 v21, 12, v19
    v_add_u32 v21, v21, v18
    v_mul_u32_u24 v20, 0, v21
    s_mul_i32 s55, s52, 0
    s_add_u32 s55, s55, s53
    v_add_u32 v20, s55, v20
    v_and_b32 v20, 31, v20
    v_lshlrev_b32 v21, 11, v21
    v_lshl_add_u32 v21, v20, 6, v21
    v_and_b32 v22, 3, v19
    v_lshl_add_u32 v21, v22, 4, v21
    s_lshl_b32 s56, s52, 15
    v_add_u32 v7, s56, v21
    s_lshr_b32 s69, s52, 1
    s_and_b32 s56, s52, 1
    s_mov_b32 s57, s12
    v_lshlrev_b32 v21, 4, v18
    v_lshl_add_u32 v21, v19, 2, v21
    s_lshl_b32 s55, s57, 6
    v_add_u32 v21, s55, v21
    v_and_b32 v22, 12, v19
    v_lshlrev_b32 v22, 27, v22
    v_add_u32 v8, v22, v21
    s_lshl_b32 s55, s69, 10
    s_lshl_b32 s56, s56, 3
    s_add_u32 s55, s55, s56
    s_add_u32 s55, s55, 135168
    v_add_u32 v9, s55, v1
    s_mov_b32 s60, 0x100000
    s_mov_b32 s61, 0x120000
    s_mov_b32 s15, 0x124000
    s_lshl_b32 s55, s57, 11
    s_add_u32 s62, s55, 0x100000
    s_mov_b32 s63, 0x182000
    s_mov_b32 s64, 0x180000
    s_mov_b32 s65, 0x180000
    s_mov_b32 s66, 0x181000
    s_mov_b32 s67, 0
    s_mov_b32 s77, s65
    s_mul_i32 s55, s53, 2097152
    s_add_u32 s68, s55, 0x2000000
    s_add_u32 s76, s68, 24576
    s_mul_i32 s55, s52, 3072
    s_add_u32 s68, s68, s55
    s_mov_b32 s74, 0x3e0293ee
    s_mov_b32 s75, 0x49800000
    s_add_u32 s78, s55, 16384
    s_and_b32 s55, s53, 0
    s_lshl_b32 s55, s55, 14
    s_add_u32 s65, s65, s55
    s_add_u32 s66, s66, s55
    s_lshl_b32 s55, s53, 7
    s_add_u32 s3, s55, 4096
    s_mov_b32 s71, 0
    v_mov_b32 v82, -1
    v_mov_b32 v83, -1
    v_mov_b32 v84, -1
    v_mov_b32 v85, -1
    s_waitcnt vmcnt(32)
    v_min_u32 v126, 0xfffe, v126
    v_lshl_add_u32 v126, v127, 16, v126
    buffer_store_dword v126, v8, s[4:7], s77 offen sc1
    buffer_store_dwordx4 v[82:85], v1, s[4:7], s62 offen sc1
    buffer_store_dwordx4 v[82:85], v1, s[4:7], s62 offen offset:1024 sc1
    buffer_store_dword v82, v8, s[4:7], s63 offen sc1
    s_lshl_b32 s55, s52, 10
    s_sub_u32 s62, s62, s55
    s_lshl_b32 s55, s52, 8
    s_add_u32 s55, s55, 131072
    v_lshl_add_u32 v1, v23, 2, s55
    s_lshl_b32 s64, s52, 12
    s_waitcnt lgkmcnt(0)
    s_mov_b32 s83, 0xa2222222
    s_waitcnt vmcnt(28)
    s_barrier
    ds_read_b64_tr_b16 v[128:129], v118 offset:0
    ds_read_b64_tr_b16 v[130:131], v118 offset:1024
    ds_read_b64_tr_b16 v[136:137], v119 offset:0
    ds_read_b64_tr_b16 v[138:139], v119 offset:1024
    ds_read_b64_tr_b16 v[144:145], v120 offset:0
    ds_read_b64_tr_b16 v[146:147], v120 offset:1024
    ds_read_b64_tr_b16 v[152:153], v121 offset:0
    ds_read_b64_tr_b16 v[154:155], v121 offset:1024
    ds_read_b64_tr_b16 v[160:161], v122 offset:0
    ds_read_b64_tr_b16 v[162:163], v122 offset:1024
    ds_read_b64_tr_b16 v[168:169], v123 offset:0
    ds_read_b64_tr_b16 v[170:171], v123 offset:1024
    s_waitcnt lgkmcnt(8)
    ds_read_b64_tr_b16 v[176:177], v124 offset:0
    ds_read_b64_tr_b16 v[178:179], v124 offset:1024
    ds_read_b64_tr_b16 v[184:185], v125 offset:0
    ds_read_b64_tr_b16 v[186:187], v125 offset:1024
    s_waitcnt lgkmcnt(0)
    s_barrier
    s_add_u32 m0, s58, 0
    s_add_u32 s55, s80, 0
    buffer_load_dwordx4 v114, s[24:27], s55 offen nt lds
    s_add_u32 m0, s58, 1024
    s_add_u32 s55, s80, 8192
    buffer_load_dwordx4 v114, s[24:27], s55 offen nt lds
    s_add_u32 m0, s58, 2048
    s_add_u32 s55, s80, 16384
    buffer_load_dwordx4 v115, s[24:27], s55 offen nt lds
    s_add_u32 m0, s58, 3072
    s_add_u32 s55, s80, 24576
    buffer_load_dwordx4 v115, s[24:27], s55 offen nt lds
    s_add_u32 m0, s58, 4096
    s_add_u32 s55, s80, 32768
    buffer_load_dwordx4 v114, s[24:27], s55 offen nt lds
    s_add_u32 m0, s58, 5120
    s_add_u32 s55, s80, 40960
    buffer_load_dwordx4 v114, s[24:27], s55 offen nt lds
    s_add_u32 m0, s58, 6144
    s_add_u32 s55, s80, 49152
    buffer_load_dwordx4 v115, s[24:27], s55 offen nt lds
    s_add_u32 m0, s58, 7168
    s_add_u32 s55, s80, 57344
    buffer_load_dwordx4 v115, s[24:27], s55 offen nt lds
    s_waitcnt vmcnt(28)
    s_barrier
    ds_read_b64_tr_b16 v[132:133], v118 offset:8192
    ds_read_b64_tr_b16 v[134:135], v118 offset:9216
    ds_read_b64_tr_b16 v[140:141], v119 offset:8192
    ds_read_b64_tr_b16 v[142:143], v119 offset:9216
    ds_read_b64_tr_b16 v[148:149], v120 offset:8192
    ds_read_b64_tr_b16 v[150:151], v120 offset:9216
    ds_read_b64_tr_b16 v[156:157], v121 offset:8192
    ds_read_b64_tr_b16 v[158:159], v121 offset:9216
    ds_read_b64_tr_b16 v[164:165], v122 offset:8192
    ds_read_b64_tr_b16 v[166:167], v122 offset:9216
    ds_read_b64_tr_b16 v[172:173], v123 offset:8192
    ds_read_b64_tr_b16 v[174:175], v123 offset:9216
    s_waitcnt lgkmcnt(8)
    ds_read_b64_tr_b16 v[180:181], v124 offset:8192
    ds_read_b64_tr_b16 v[182:183], v124 offset:9216
    ds_read_b64_tr_b16 v[188:189], v125 offset:8192
    ds_read_b64_tr_b16 v[190:191], v125 offset:9216
    s_waitcnt lgkmcnt(0)
    s_barrier
    s_add_u32 m0, s58, 8192
    s_add_u32 s55, s80, 65536
    buffer_load_dwordx4 v114, s[24:27], s55 offen nt lds
    s_add_u32 m0, s58, 9216
    s_add_u32 s55, s80, 73728
    buffer_load_dwordx4 v114, s[24:27], s55 offen nt lds
    s_add_u32 m0, s58, 10240
    s_add_u32 s55, s80, 81920
    buffer_load_dwordx4 v115, s[24:27], s55 offen nt lds
    s_add_u32 m0, s58, 11264
    s_add_u32 s55, s80, 90112
    buffer_load_dwordx4 v115, s[24:27], s55 offen nt lds
    s_add_u32 m0, s58, 12288
    s_add_u32 s55, s80, 98304
    buffer_load_dwordx4 v114, s[24:27], s55 offen nt lds
    s_add_u32 m0, s58, 13312
    s_add_u32 s55, s80, 106496
    buffer_load_dwordx4 v114, s[24:27], s55 offen nt lds
    s_add_u32 m0, s58, 14336
    s_add_u32 s55, s80, 114688
    buffer_load_dwordx4 v115, s[24:27], s55 offen nt lds
    s_add_u32 m0, s58, 15360
    s_add_u32 s55, s80, 122880
    buffer_load_dwordx4 v115, s[24:27], s55 offen nt lds
    ds_write_b128 v11, v[128:131] offset:8192
    ds_write_b128 v11, v[132:135] offset:12288
    ds_write_b128 v11, v[136:139] offset:16384
    ds_write_b128 v11, v[140:143] offset:20480
    s_waitcnt lgkmcnt(0)
    s_waitcnt vmcnt(28)
    s_barrier
    ds_read_b64_tr_b16 v[18:19], v118 offset:16384
    ds_read_b64_tr_b16 v[20:21], v118 offset:17408
    ds_read_b64_tr_b16 v[26:27], v119 offset:16384
    ds_read_b64_tr_b16 v[28:29], v119 offset:17408
    ds_read_b64_tr_b16 v[192:193], v120 offset:16384
    ds_read_b64_tr_b16 v[194:195], v120 offset:17408
    ds_read_b64_tr_b16 v[200:201], v121 offset:16384
    ds_read_b64_tr_b16 v[202:203], v121 offset:17408
    ds_read_b64_tr_b16 v[34:35], v122 offset:16384
    ds_read_b64_tr_b16 v[36:37], v122 offset:17408
    ds_read_b64_tr_b16 v[42:43], v123 offset:16384
    ds_read_b64_tr_b16 v[44:45], v123 offset:17408
    s_waitcnt lgkmcnt(8)
    ds_read_b64_tr_b16 v[208:209], v124 offset:16384
    ds_read_b64_tr_b16 v[210:211], v124 offset:17408
    ds_read_b64_tr_b16 v[216:217], v125 offset:16384
    ds_read_b64_tr_b16 v[218:219], v125 offset:17408
    s_waitcnt lgkmcnt(0)
    s_barrier
    s_add_u32 m0, s58, 16384
    s_add_u32 s55, s80, 524288
    buffer_load_dwordx4 v16, s[24:27], s55 offen nt lds
    s_add_u32 m0, s58, 17408
    s_add_u32 s55, s80, 540672
    buffer_load_dwordx4 v16, s[24:27], s55 offen nt lds
    s_add_u32 m0, s58, 18432
    s_add_u32 s55, s80, 557056
    buffer_load_dwordx4 v17, s[24:27], s55 offen nt lds
    s_add_u32 m0, s58, 19456
    s_add_u32 s55, s80, 573440
    buffer_load_dwordx4 v17, s[24:27], s55 offen nt lds
    s_add_u32 m0, s58, 20480
    s_add_u32 s55, s80, 589824
    buffer_load_dwordx4 v16, s[24:27], s55 offen nt lds
    s_add_u32 m0, s58, 21504
    s_add_u32 s55, s80, 606208
    buffer_load_dwordx4 v16, s[24:27], s55 offen nt lds
    s_add_u32 m0, s58, 22528
    s_add_u32 s55, s80, 622592
    buffer_load_dwordx4 v17, s[24:27], s55 offen nt lds
    s_add_u32 m0, s58, 23552
    s_add_u32 s55, s80, 638976
    buffer_load_dwordx4 v17, s[24:27], s55 offen nt lds
    s_waitcnt vmcnt(24)
    s_mov_b64 exec, 1
    v_mov_b32 v126, 0
    v_mov_b32 v127, 1
    buffer_atomic_add v127, v126, s[8:11], 0 offen offset:8 sc1
    s_mov_b64 exec, -1
    s_barrier
    ds_read_b64_tr_b16 v[22:23], v118 offset:24576
    ds_read_b64_tr_b16 v[24:25], v118 offset:25600
    ds_read_b64_tr_b16 v[30:31], v119 offset:24576
    ds_read_b64_tr_b16 v[32:33], v119 offset:25600
    ds_read_b64_tr_b16 v[196:197], v120 offset:24576
    ds_read_b64_tr_b16 v[198:199], v120 offset:25600
    ds_read_b64_tr_b16 v[204:205], v121 offset:24576
    ds_read_b64_tr_b16 v[206:207], v121 offset:25600
    ds_read_b64_tr_b16 v[38:39], v122 offset:24576
    ds_read_b64_tr_b16 v[40:41], v122 offset:25600
    ds_read_b64_tr_b16 v[46:47], v123 offset:24576
    ds_read_b64_tr_b16 v[48:49], v123 offset:25600
    s_waitcnt lgkmcnt(8)
    ds_read_b64_tr_b16 v[212:213], v124 offset:24576
    ds_read_b64_tr_b16 v[214:215], v124 offset:25600
    ds_read_b64_tr_b16 v[220:221], v125 offset:24576
    ds_read_b64_tr_b16 v[222:223], v125 offset:25600
    s_waitcnt lgkmcnt(0)
    s_barrier
    s_add_u32 m0, s58, 24576
    s_add_u32 s55, s80, 786432
    buffer_load_dwordx4 v16, s[24:27], s55 offen nt lds
    s_add_u32 m0, s58, 25600
    s_add_u32 s55, s80, 802816
    buffer_load_dwordx4 v16, s[24:27], s55 offen nt lds
    s_add_u32 m0, s58, 26624
    s_add_u32 s55, s80, 819200
    buffer_load_dwordx4 v17, s[24:27], s55 offen nt lds
    s_add_u32 m0, s58, 27648
    s_add_u32 s55, s80, 835584
    buffer_load_dwordx4 v17, s[24:27], s55 offen nt lds
    s_add_u32 m0, s58, 28672
    s_add_u32 s55, s80, 851968
    buffer_load_dwordx4 v16, s[24:27], s55 offen nt lds
    s_add_u32 m0, s58, 29696
    s_add_u32 s55, s80, 868352
    buffer_load_dwordx4 v16, s[24:27], s55 offen nt lds
    s_add_u32 m0, s58, 30720
    s_add_u32 s55, s80, 884736
    buffer_load_dwordx4 v17, s[24:27], s55 offen nt lds
    s_add_u32 m0, s58, 31744
    s_add_u32 s55, s80, 901120
    buffer_load_dwordx4 v17, s[24:27], s55 offen nt lds
    s_waitcnt vmcnt(24)
    s_barrier
    ds_read_b64_tr_b16 v[224:225], v118 offset:0
    ds_read_b64_tr_b16 v[226:227], v118 offset:1024
    ds_read_b64_tr_b16 v[232:233], v119 offset:0
    ds_read_b64_tr_b16 v[234:235], v119 offset:1024
    ds_read_b64_tr_b16 v[50:51], v120 offset:0
    ds_read_b64_tr_b16 v[52:53], v120 offset:1024
    ds_read_b64_tr_b16 v[58:59], v121 offset:0
    ds_read_b64_tr_b16 v[60:61], v121 offset:1024
    ds_read_b64_tr_b16 v[66:67], v122 offset:0
    ds_read_b64_tr_b16 v[68:69], v122 offset:1024
    ds_read_b64_tr_b16 v[74:75], v123 offset:0
    ds_read_b64_tr_b16 v[76:77], v123 offset:1024
    s_waitcnt lgkmcnt(8)
    ds_read_b64_tr_b16 v[240:241], v124 offset:0
    ds_read_b64_tr_b16 v[242:243], v124 offset:1024
    ds_read_b64_tr_b16 v[248:249], v125 offset:0
    ds_read_b64_tr_b16 v[250:251], v125 offset:1024
    s_waitcnt lgkmcnt(0)
    s_barrier
    s_add_u32 m0, s58, 0
    s_add_u32 s55, s80, 0
    buffer_load_dwordx4 v114, s[28:31], s55 offen nt lds
    s_add_u32 m0, s58, 1024
    s_add_u32 s55, s80, 8192
    buffer_load_dwordx4 v114, s[28:31], s55 offen nt lds
    s_add_u32 m0, s58, 2048
    s_add_u32 s55, s80, 16384
    buffer_load_dwordx4 v115, s[28:31], s55 offen nt lds
    s_add_u32 m0, s58, 3072
    s_add_u32 s55, s80, 24576
    buffer_load_dwordx4 v115, s[28:31], s55 offen nt lds
    s_add_u32 m0, s58, 4096
    s_add_u32 s55, s80, 32768
    buffer_load_dwordx4 v114, s[28:31], s55 offen nt lds
    s_add_u32 m0, s58, 5120
    s_add_u32 s55, s80, 40960
    buffer_load_dwordx4 v114, s[28:31], s55 offen nt lds
    s_add_u32 m0, s58, 6144
    s_add_u32 s55, s80, 49152
    buffer_load_dwordx4 v115, s[28:31], s55 offen nt lds
    s_add_u32 m0, s58, 7168
    s_add_u32 s55, s80, 57344
    buffer_load_dwordx4 v115, s[28:31], s55 offen nt lds
    s_waitcnt vmcnt(24)
    s_barrier
    ds_read_b64_tr_b16 v[228:229], v118 offset:8192
    ds_read_b64_tr_b16 v[230:231], v118 offset:9216
    ds_read_b64_tr_b16 v[236:237], v119 offset:8192
    ds_read_b64_tr_b16 v[238:239], v119 offset:9216
    ds_read_b64_tr_b16 v[54:55], v120 offset:8192
    ds_read_b64_tr_b16 v[56:57], v120 offset:9216
    ds_read_b64_tr_b16 v[62:63], v121 offset:8192
    ds_read_b64_tr_b16 v[64:65], v121 offset:9216
    ds_read_b64_tr_b16 v[70:71], v122 offset:8192
    ds_read_b64_tr_b16 v[72:73], v122 offset:9216
    ds_read_b64_tr_b16 v[78:79], v123 offset:8192
    ds_read_b64_tr_b16 v[80:81], v123 offset:9216
    s_waitcnt lgkmcnt(8)
    ds_read_b64_tr_b16 v[244:245], v124 offset:8192
    ds_read_b64_tr_b16 v[246:247], v124 offset:9216
    ds_read_b64_tr_b16 v[252:253], v125 offset:8192
    ds_read_b64_tr_b16 v[254:255], v125 offset:9216
    s_waitcnt lgkmcnt(0)
    s_barrier
    s_add_u32 m0, s58, 8192
    s_add_u32 s55, s80, 65536
    buffer_load_dwordx4 v114, s[28:31], s55 offen nt lds
    s_add_u32 m0, s58, 9216
    s_add_u32 s55, s80, 73728
    buffer_load_dwordx4 v114, s[28:31], s55 offen nt lds
    s_add_u32 m0, s58, 10240
    s_add_u32 s55, s80, 81920
    buffer_load_dwordx4 v115, s[28:31], s55 offen nt lds
    s_add_u32 m0, s58, 11264
    s_add_u32 s55, s80, 90112
    buffer_load_dwordx4 v115, s[28:31], s55 offen nt lds
    s_add_u32 m0, s58, 12288
    s_add_u32 s55, s80, 98304
    buffer_load_dwordx4 v114, s[28:31], s55 offen nt lds
    s_add_u32 m0, s58, 13312
    s_add_u32 s55, s80, 106496
    buffer_load_dwordx4 v114, s[28:31], s55 offen nt lds
    s_add_u32 m0, s58, 14336
    s_add_u32 s55, s80, 114688
    buffer_load_dwordx4 v115, s[28:31], s55 offen nt lds
    s_add_u32 m0, s58, 15360
    s_add_u32 s55, s80, 122880
    buffer_load_dwordx4 v115, s[28:31], s55 offen nt lds
    s_waitcnt vmcnt(24)
    s_barrier
    ds_read_b64_tr_b16 a[0:1], v118 offset:16384
    ds_read_b64_tr_b16 a[2:3], v118 offset:17408
    ds_read_b64_tr_b16 a[8:9], v119 offset:16384
    ds_read_b64_tr_b16 a[10:11], v119 offset:17408
    ds_read_b64_tr_b16 a[16:17], v120 offset:16384
    ds_read_b64_tr_b16 a[18:19], v120 offset:17408
    ds_read_b64_tr_b16 a[24:25], v121 offset:16384
    ds_read_b64_tr_b16 a[26:27], v121 offset:17408
    ds_read_b64_tr_b16 a[32:33], v122 offset:16384
    ds_read_b64_tr_b16 a[34:35], v122 offset:17408
    ds_read_b64_tr_b16 a[40:41], v123 offset:16384
    ds_read_b64_tr_b16 a[42:43], v123 offset:17408
    s_waitcnt lgkmcnt(8)
    ds_read_b64_tr_b16 a[48:49], v124 offset:16384
    ds_read_b64_tr_b16 a[50:51], v124 offset:17408
    ds_read_b64_tr_b16 a[56:57], v125 offset:16384
    ds_read_b64_tr_b16 a[58:59], v125 offset:17408
    s_waitcnt lgkmcnt(0)
    s_barrier
    s_add_u32 m0, s58, 16384
    s_add_u32 s55, s81, 0
    buffer_load_dwordx4 v116, s[32:35], s55 offen nt lds
    s_add_u32 m0, s58, 17408
    s_add_u32 s55, s81, 2048
    buffer_load_dwordx4 v116, s[32:35], s55 offen nt lds
    s_add_u32 m0, s58, 18432
    s_add_u32 s55, s81, 32768
    buffer_load_dwordx4 v117, s[32:35], s55 offen nt lds
    s_add_u32 m0, s58, 19456
    s_add_u32 s55, s81, 34816
    buffer_load_dwordx4 v117, s[32:35], s55 offen nt lds
    s_add_u32 m0, s58, 20480
    s_add_u32 s55, s81, 4096
    buffer_load_dwordx4 v116, s[32:35], s55 offen nt lds
    s_add_u32 m0, s58, 21504
    s_add_u32 s55, s81, 6144
    buffer_load_dwordx4 v116, s[32:35], s55 offen nt lds
    s_add_u32 m0, s58, 22528
    s_add_u32 s55, s81, 36864
    buffer_load_dwordx4 v117, s[32:35], s55 offen nt lds
    s_add_u32 m0, s58, 23552
    s_add_u32 s55, s81, 38912
    buffer_load_dwordx4 v117, s[32:35], s55 offen nt lds
    s_waitcnt vmcnt(24)
    s_barrier
    ds_read_b64_tr_b16 a[4:5], v118 offset:24576
    ds_read_b64_tr_b16 a[6:7], v118 offset:25600
    ds_read_b64_tr_b16 a[12:13], v119 offset:24576
    ds_read_b64_tr_b16 a[14:15], v119 offset:25600
    ds_read_b64_tr_b16 a[20:21], v120 offset:24576
    ds_read_b64_tr_b16 a[22:23], v120 offset:25600
    ds_read_b64_tr_b16 a[28:29], v121 offset:24576
    ds_read_b64_tr_b16 a[30:31], v121 offset:25600
    ds_read_b64_tr_b16 a[36:37], v122 offset:24576
    ds_read_b64_tr_b16 a[38:39], v122 offset:25600
    ds_read_b64_tr_b16 a[44:45], v123 offset:24576
    ds_read_b64_tr_b16 a[46:47], v123 offset:25600
    s_waitcnt lgkmcnt(8)
    ds_read_b64_tr_b16 a[52:53], v124 offset:24576
    ds_read_b64_tr_b16 a[54:55], v124 offset:25600
    ds_read_b64_tr_b16 a[60:61], v125 offset:24576
    ds_read_b64_tr_b16 a[62:63], v125 offset:25600
    s_waitcnt lgkmcnt(0)
    s_barrier
    s_add_u32 m0, s58, 24576
    s_add_u32 s55, s81, 8192
    buffer_load_dwordx4 v116, s[32:35], s55 offen nt lds
    s_add_u32 m0, s58, 25600
    s_add_u32 s55, s81, 10240
    buffer_load_dwordx4 v116, s[32:35], s55 offen nt lds
    s_add_u32 m0, s58, 26624
    s_add_u32 s55, s81, 40960
    buffer_load_dwordx4 v117, s[32:35], s55 offen nt lds
    s_add_u32 m0, s58, 27648
    s_add_u32 s55, s81, 43008
    buffer_load_dwordx4 v117, s[32:35], s55 offen nt lds
    s_add_u32 m0, s58, 28672
    s_add_u32 s55, s81, 12288
    buffer_load_dwordx4 v116, s[32:35], s55 offen nt lds
    s_add_u32 m0, s58, 29696
    s_add_u32 s55, s81, 14336
    buffer_load_dwordx4 v116, s[32:35], s55 offen nt lds
    s_add_u32 m0, s58, 30720
    s_add_u32 s55, s81, 45056
    buffer_load_dwordx4 v117, s[32:35], s55 offen nt lds
    s_add_u32 m0, s58, 31744
    s_add_u32 s55, s81, 47104
    buffer_load_dwordx4 v117, s[32:35], s55 offen nt lds
    s_waitcnt vmcnt(24)
    s_barrier
    ds_read_b64_tr_b16 a[64:65], v118 offset:0
    ds_read_b64_tr_b16 a[66:67], v118 offset:1024
    ds_read_b64_tr_b16 a[72:73], v119 offset:0
    ds_read_b64_tr_b16 a[74:75], v119 offset:1024
    ds_read_b64_tr_b16 a[80:81], v120 offset:0
    ds_read_b64_tr_b16 a[82:83], v120 offset:1024
    ds_read_b64_tr_b16 a[88:89], v121 offset:0
    ds_read_b64_tr_b16 a[90:91], v121 offset:1024
    ds_read_b64_tr_b16 a[96:97], v122 offset:0
    ds_read_b64_tr_b16 a[98:99], v122 offset:1024
    ds_read_b64_tr_b16 a[104:105], v123 offset:0
    ds_read_b64_tr_b16 a[106:107], v123 offset:1024
    s_waitcnt lgkmcnt(8)
    ds_read_b64_tr_b16 a[112:113], v124 offset:0
    ds_read_b64_tr_b16 a[114:115], v124 offset:1024
    ds_read_b64_tr_b16 a[120:121], v125 offset:0
    ds_read_b64_tr_b16 a[122:123], v125 offset:1024
    s_waitcnt lgkmcnt(0)
    s_barrier
    s_add_u32 m0, s58, 0
    s_add_u32 s55, s81, 65536
    buffer_load_dwordx4 v116, s[32:35], s55 offen nt lds
    s_add_u32 m0, s58, 1024
    s_add_u32 s55, s81, 67584
    buffer_load_dwordx4 v116, s[32:35], s55 offen nt lds
    s_add_u32 m0, s58, 2048
    s_add_u32 s55, s81, 98304
    buffer_load_dwordx4 v117, s[32:35], s55 offen nt lds
    s_add_u32 m0, s58, 3072
    s_add_u32 s55, s81, 100352
    buffer_load_dwordx4 v117, s[32:35], s55 offen nt lds
    s_add_u32 m0, s58, 4096
    s_add_u32 s55, s81, 69632
    buffer_load_dwordx4 v116, s[32:35], s55 offen nt lds
    s_add_u32 m0, s58, 5120
    s_add_u32 s55, s81, 71680
    buffer_load_dwordx4 v116, s[32:35], s55 offen nt lds
    s_add_u32 m0, s58, 6144
    s_add_u32 s55, s81, 102400
    buffer_load_dwordx4 v117, s[32:35], s55 offen nt lds
    s_add_u32 m0, s58, 7168
    s_add_u32 s55, s81, 104448
    buffer_load_dwordx4 v117, s[32:35], s55 offen nt lds
    s_waitcnt vmcnt(24)
    s_barrier
    ds_read_b64_tr_b16 a[68:69], v118 offset:8192
    ds_read_b64_tr_b16 a[70:71], v118 offset:9216
    ds_read_b64_tr_b16 a[76:77], v119 offset:8192
    ds_read_b64_tr_b16 a[78:79], v119 offset:9216
    ds_read_b64_tr_b16 a[84:85], v120 offset:8192
    ds_read_b64_tr_b16 a[86:87], v120 offset:9216
    ds_read_b64_tr_b16 a[92:93], v121 offset:8192
    ds_read_b64_tr_b16 a[94:95], v121 offset:9216
    ds_read_b64_tr_b16 a[100:101], v122 offset:8192
    ds_read_b64_tr_b16 a[102:103], v122 offset:9216
    ds_read_b64_tr_b16 a[108:109], v123 offset:8192
    ds_read_b64_tr_b16 a[110:111], v123 offset:9216
    s_waitcnt lgkmcnt(8)
    ds_read_b64_tr_b16 a[116:117], v124 offset:8192
    ds_read_b64_tr_b16 a[118:119], v124 offset:9216
    ds_read_b64_tr_b16 a[124:125], v125 offset:8192
    ds_read_b64_tr_b16 a[126:127], v125 offset:9216
    s_waitcnt lgkmcnt(0)
    s_barrier
    s_add_u32 m0, s58, 8192
    s_add_u32 s55, s81, 73728
    buffer_load_dwordx4 v116, s[32:35], s55 offen nt lds
    s_add_u32 m0, s58, 9216
    s_add_u32 s55, s81, 75776
    buffer_load_dwordx4 v116, s[32:35], s55 offen nt lds
    s_add_u32 m0, s58, 10240
    s_add_u32 s55, s81, 106496
    buffer_load_dwordx4 v117, s[32:35], s55 offen nt lds
    s_add_u32 m0, s58, 11264
    s_add_u32 s55, s81, 108544
    buffer_load_dwordx4 v117, s[32:35], s55 offen nt lds
    s_add_u32 m0, s58, 12288
    s_add_u32 s55, s81, 77824
    buffer_load_dwordx4 v116, s[32:35], s55 offen nt lds
    s_add_u32 m0, s58, 13312
    s_add_u32 s55, s81, 79872
    buffer_load_dwordx4 v116, s[32:35], s55 offen nt lds
    s_add_u32 m0, s58, 14336
    s_add_u32 s55, s81, 110592
    buffer_load_dwordx4 v117, s[32:35], s55 offen nt lds
    s_add_u32 m0, s58, 15360
    s_add_u32 s55, s81, 112640
    buffer_load_dwordx4 v117, s[32:35], s55 offen nt lds
    s_waitcnt vmcnt(24)
    s_barrier
    s_xor_b32 s55, s52, 0
    s_lshl_b32 s55, s55, 6
    v_xor_b32 v128, s55, v118
    v_xor_b32 v129, s55, v119
    ds_read_b64_tr_b16 a[160:161], v128 offset:16384
    ds_read_b64_tr_b16 a[162:163], v128 offset:17408
    ds_read_b64_tr_b16 a[168:169], v129 offset:16384
    ds_read_b64_tr_b16 a[170:171], v129 offset:17408
    s_xor_b32 s55, s52, 1
    s_lshl_b32 s55, s55, 6
    v_xor_b32 v130, s55, v118
    v_xor_b32 v131, s55, v119
    ds_read_b64_tr_b16 a[176:177], v130 offset:16384
    ds_read_b64_tr_b16 a[178:179], v130 offset:17408
    ds_read_b64_tr_b16 a[184:185], v131 offset:16384
    ds_read_b64_tr_b16 a[186:187], v131 offset:17408
    s_xor_b32 s55, s52, 2
    s_lshl_b32 s55, s55, 6
    v_xor_b32 v132, s55, v118
    v_xor_b32 v133, s55, v119
    ds_read_b64_tr_b16 a[192:193], v132 offset:16384
    ds_read_b64_tr_b16 a[194:195], v132 offset:17408
    ds_read_b64_tr_b16 a[200:201], v133 offset:16384
    ds_read_b64_tr_b16 a[202:203], v133 offset:17408
    s_waitcnt lgkmcnt(8)
    s_xor_b32 s55, s52, 3
    s_lshl_b32 s55, s55, 6
    v_xor_b32 v134, s55, v118
    v_xor_b32 v135, s55, v119
    ds_read_b64_tr_b16 v[82:83], v134 offset:16384
    ds_read_b64_tr_b16 v[84:85], v134 offset:17408
    ds_read_b64_tr_b16 v[90:91], v135 offset:16384
    ds_read_b64_tr_b16 v[92:93], v135 offset:17408
    s_waitcnt lgkmcnt(0)
    s_barrier
    s_add_u32 m0, s58, 16384
    s_add_u32 s55, s80, 524288
    buffer_load_dwordx4 v16, s[28:31], s55 offen nt lds
    s_add_u32 m0, s58, 17408
    s_add_u32 s55, s80, 540672
    buffer_load_dwordx4 v16, s[28:31], s55 offen nt lds
    s_add_u32 m0, s58, 18432
    s_add_u32 s55, s80, 557056
    buffer_load_dwordx4 v17, s[28:31], s55 offen nt lds
    s_add_u32 m0, s58, 19456
    s_add_u32 s55, s80, 573440
    buffer_load_dwordx4 v17, s[28:31], s55 offen nt lds
    s_add_u32 m0, s58, 20480
    s_add_u32 s55, s80, 589824
    buffer_load_dwordx4 v16, s[28:31], s55 offen nt lds
    s_add_u32 m0, s58, 21504
    s_add_u32 s55, s80, 606208
    buffer_load_dwordx4 v16, s[28:31], s55 offen nt lds
    s_add_u32 m0, s58, 22528
    s_add_u32 s55, s80, 622592
    buffer_load_dwordx4 v17, s[28:31], s55 offen nt lds
    s_add_u32 m0, s58, 23552
    s_add_u32 s55, s80, 638976
    buffer_load_dwordx4 v17, s[28:31], s55 offen nt lds
    s_load_dwordx4 s[88:91], s[8:9], 8 glc
    s_waitcnt vmcnt(24)
    s_barrier
    ds_read_b64_tr_b16 a[164:165], v128 offset:24576
    ds_read_b64_tr_b16 a[166:167], v128 offset:25600
    ds_read_b64_tr_b16 a[172:173], v129 offset:24576
    ds_read_b64_tr_b16 a[174:175], v129 offset:25600
    ds_read_b64_tr_b16 a[180:181], v130 offset:24576
    ds_read_b64_tr_b16 a[182:183], v130 offset:25600
    ds_read_b64_tr_b16 a[188:189], v131 offset:24576
    ds_read_b64_tr_b16 a[190:191], v131 offset:25600
    ds_read_b64_tr_b16 a[196:197], v132 offset:24576
    ds_read_b64_tr_b16 a[198:199], v132 offset:25600
    ds_read_b64_tr_b16 a[204:205], v133 offset:24576
    ds_read_b64_tr_b16 a[206:207], v133 offset:25600
    s_waitcnt lgkmcnt(8)
    ds_read_b64_tr_b16 v[86:87], v134 offset:24576
    ds_read_b64_tr_b16 v[88:89], v134 offset:25600
    ds_read_b64_tr_b16 v[94:95], v135 offset:24576
    ds_read_b64_tr_b16 v[96:97], v135 offset:25600
    s_waitcnt lgkmcnt(0)
    s_barrier
    s_add_u32 m0, s58, 24576
    s_add_u32 s55, s80, 786432
    buffer_load_dwordx4 v16, s[28:31], s55 offen nt lds
    s_add_u32 m0, s58, 25600
    s_add_u32 s55, s80, 802816
    buffer_load_dwordx4 v16, s[28:31], s55 offen nt lds
    s_add_u32 m0, s58, 26624
    s_add_u32 s55, s80, 819200
    buffer_load_dwordx4 v17, s[28:31], s55 offen nt lds
    s_add_u32 m0, s58, 27648
    s_add_u32 s55, s80, 835584
    buffer_load_dwordx4 v17, s[28:31], s55 offen nt lds
    s_add_u32 m0, s58, 28672
    s_add_u32 s55, s80, 851968
    buffer_load_dwordx4 v16, s[28:31], s55 offen nt lds
    s_add_u32 m0, s58, 29696
    s_add_u32 s55, s80, 868352
    buffer_load_dwordx4 v16, s[28:31], s55 offen nt lds
    s_add_u32 m0, s58, 30720
    s_add_u32 s55, s80, 884736
    buffer_load_dwordx4 v17, s[28:31], s55 offen nt lds
    s_add_u32 m0, s58, 31744
    s_add_u32 s55, s80, 901120
    buffer_load_dwordx4 v17, s[28:31], s55 offen nt lds
    s_waitcnt vmcnt(24)
    s_barrier
    s_xor_b32 s55, s52, 0
    s_lshl_b32 s55, s55, 6
    v_xor_b32 v128, s55, v118
    v_xor_b32 v129, s55, v119
    ds_read_b64_tr_b16 a[208:209], v128 offset:0
    ds_read_b64_tr_b16 a[210:211], v128 offset:1024
    ds_read_b64_tr_b16 a[216:217], v129 offset:0
    ds_read_b64_tr_b16 a[218:219], v129 offset:1024
    s_xor_b32 s55, s52, 1
    s_lshl_b32 s55, s55, 6
    v_xor_b32 v130, s55, v118
    v_xor_b32 v131, s55, v119
    ds_read_b64_tr_b16 a[224:225], v130 offset:0
    ds_read_b64_tr_b16 a[226:227], v130 offset:1024
    ds_read_b64_tr_b16 a[232:233], v131 offset:0
    ds_read_b64_tr_b16 a[234:235], v131 offset:1024
    s_xor_b32 s55, s52, 2
    s_lshl_b32 s55, s55, 6
    v_xor_b32 v132, s55, v118
    v_xor_b32 v133, s55, v119
    ds_read_b64_tr_b16 a[240:241], v132 offset:0
    ds_read_b64_tr_b16 a[242:243], v132 offset:1024
    ds_read_b64_tr_b16 a[248:249], v133 offset:0
    ds_read_b64_tr_b16 a[250:251], v133 offset:1024
    s_waitcnt lgkmcnt(8)
    s_xor_b32 s55, s52, 3
    s_lshl_b32 s55, s55, 6
    v_xor_b32 v134, s55, v118
    v_xor_b32 v135, s55, v119
    ds_read_b64_tr_b16 v[98:99], v134 offset:0
    ds_read_b64_tr_b16 v[100:101], v134 offset:1024
    ds_read_b64_tr_b16 v[106:107], v135 offset:0
    ds_read_b64_tr_b16 v[108:109], v135 offset:1024
    s_waitcnt lgkmcnt(0)
    s_barrier
    ds_write_b128 v15, v[50:53] offset:0
    ds_write_b128 v15, v[54:57] offset:1024
    ds_write_b128 v15, v[58:61] offset:2048
    ds_write_b128 v15, v[62:65] offset:3072
    ds_write_b128 v15, v[66:69] offset:4096
    ds_write_b128 v15, v[70:73] offset:5120
    ds_write_b128 v15, v[74:77] offset:6144
    ds_write_b128 v15, v[78:81] offset:7168
    s_waitcnt lgkmcnt(0)
    s_mov_b32 s91, 0
L_arm_wait:
    s_cmp_lg_u32 s90, 0
    s_cselect_b32 s88, s88, 0
    s_cmp_ge_u32 s88, 128
    s_cbranch_scc1 L_armed
    s_sub_u32 s59, s59, 1
    s_cbranch_scc1 L_timeout
    s_sleep 8
    s_load_dwordx2 s[88:89], s[8:9], 8 glc
    s_load_dword s90, s[8:9], 16 glc
    s_waitcnt lgkmcnt(0)
    s_branch L_arm_wait
L_armed:
    s_waitcnt vmcnt(16)
    s_barrier
    ds_read_b64_tr_b16 a[212:213], v128 offset:8192
    ds_read_b64_tr_b16 a[214:215], v128 offset:9216
    ds_read_b64_tr_b16 a[220:221], v129 offset:8192
    ds_read_b64_tr_b16 a[222:223], v129 offset:9216
    ds_read_b64_tr_b16 a[228:229], v130 offset:8192
    ds_read_b64_tr_b16 a[230:231], v130 offset:9216
    ds_read_b64_tr_b16 a[236:237], v131 offset:8192
    ds_read_b64_tr_b16 a[238:239], v131 offset:9216
    ds_read_b64_tr_b16 a[244:245], v132 offset:8192
    ds_read_b64_tr_b16 a[246:247], v132 offset:9216
    ds_read_b64_tr_b16 a[252:253], v133 offset:8192
    ds_read_b64_tr_b16 a[254:255], v133 offset:9216
    s_waitcnt lgkmcnt(8)
    ds_read_b64_tr_b16 v[102:103], v134 offset:8192
    ds_read_b64_tr_b16 v[104:105], v134 offset:9216
    ds_read_b64_tr_b16 v[110:111], v135 offset:8192
    ds_read_b64_tr_b16 v[112:113], v135 offset:9216
    s_waitcnt lgkmcnt(0)
    s_barrier
    ds_write_b128 v15, v[18:21] offset:8192
    ds_write_b128 v15, v[22:25] offset:9216
    ds_write_b128 v15, v[26:29] offset:10240
    ds_write_b128 v15, v[30:33] offset:11264
    ds_write_b128 v15, v[34:37] offset:12288
    ds_write_b128 v15, v[38:41] offset:13312
    ds_write_b128 v15, v[42:45] offset:14336
    ds_write_b128 v15, v[46:49] offset:15360
    s_waitcnt lgkmcnt(0)
    buffer_load_dwordx4 v[18:21], v10, s[4:7], s65 offen sc1
    buffer_load_dwordx4 v[34:37], v10, s[4:7], s66 offen sc1
    s_waitcnt vmcnt(10)
    s_barrier
    ds_read_b64_tr_b16 a[128:129], v118 offset:16384
    ds_read_b64_tr_b16 a[130:131], v118 offset:17408
    ds_read_b64_tr_b16 a[136:137], v119 offset:16384
    ds_read_b64_tr_b16 a[138:139], v119 offset:17408
    ds_read_b64_tr_b16 a[144:145], v120 offset:16384
    ds_read_b64_tr_b16 a[146:147], v120 offset:17408
    ds_read_b64_tr_b16 a[152:153], v121 offset:16384
    ds_read_b64_tr_b16 a[154:155], v121 offset:17408
    ds_read_b64_tr_b16 v[50:51], v122 offset:16384
    ds_read_b64_tr_b16 v[52:53], v122 offset:17408
    ds_read_b64_tr_b16 v[58:59], v123 offset:16384
    ds_read_b64_tr_b16 v[60:61], v123 offset:17408
    s_waitcnt lgkmcnt(8)
    ds_read_b64_tr_b16 v[66:67], v124 offset:16384
    ds_read_b64_tr_b16 v[68:69], v124 offset:17408
    ds_read_b64_tr_b16 v[74:75], v125 offset:16384
    ds_read_b64_tr_b16 v[76:77], v125 offset:17408
    s_waitcnt lgkmcnt(0)
    s_barrier
    ds_write_b128 v15, v[82:85] offset:16384
    ds_write_b128 v15, v[86:89] offset:17408
    ds_write_b128 v15, v[90:93] offset:18432
    ds_write_b128 v15, v[94:97] offset:19456
    ds_write_b128 v15, v[98:101] offset:20480
    ds_write_b128 v15, v[102:105] offset:21504
    ds_write_b128 v15, v[106:109] offset:22528
    ds_write_b128 v15, v[110:113] offset:23552
    s_waitcnt lgkmcnt(0)
    s_cmp_lg_u32 s91, 0
    s_cbranch_scc1 L_kv0_no2
    s_load_dwordx4 s[84:87], s[4:5], s3 glc
L_kv0_no2:
    s_waitcnt vmcnt(2)
    s_cmp_lg_u32 s91, 0
    s_cbranch_scc1 L_kv0_late
    s_waitcnt lgkmcnt(0)
    s_min_u32 s84, s84, s85
    s_min_u32 s84, s84, s86
    s_cmp_gt_u32 s84, 1
    s_cbranch_scc0 L_kv0_late
    buffer_load_dwordx4 v[128:131], v6, s[4:7], s68 offen offset:0 sc1
    buffer_load_dwordx4 v[132:135], v6, s[4:7], s68 offen offset:512 sc1
    buffer_load_dwordx4 v[136:139], v10, s[4:7], s68 offen offset:2048 sc1
    buffer_load_dwordx4 v[140:143], v10, s[4:7], s68 offen offset:3072 sc1
    s_mov_b32 s91, 1
L_kv0_late:
    s_barrier
    ds_read_b64_tr_b16 a[132:133], v118 offset:24576
    ds_read_b64_tr_b16 a[134:135], v118 offset:25600
    ds_read_b64_tr_b16 a[140:141], v119 offset:24576
    ds_read_b64_tr_b16 a[142:143], v119 offset:25600
    ds_read_b64_tr_b16 a[148:149], v120 offset:24576
    ds_read_b64_tr_b16 a[150:151], v120 offset:25600
    ds_read_b64_tr_b16 a[156:157], v121 offset:24576
    ds_read_b64_tr_b16 a[158:159], v121 offset:25600
    ds_read_b64_tr_b16 v[54:55], v122 offset:24576
    ds_read_b64_tr_b16 v[56:57], v122 offset:25600
    ds_read_b64_tr_b16 v[62:63], v123 offset:24576
    ds_read_b64_tr_b16 v[64:65], v123 offset:25600
    s_waitcnt lgkmcnt(8)
    ds_read_b64_tr_b16 v[70:71], v124 offset:24576
    ds_read_b64_tr_b16 v[72:73], v124 offset:25600
    ds_read_b64_tr_b16 v[78:79], v125 offset:24576
    ds_read_b64_tr_b16 v[80:81], v125 offset:25600
    s_waitcnt lgkmcnt(0)
    s_barrier
    ds_write_b128 v15, v[50:53] offset:24576
    ds_write_b128 v15, v[54:57] offset:25600
    ds_write_b128 v15, v[58:61] offset:26624
    ds_write_b128 v15, v[62:65] offset:27648
    ds_write_b128 v15, v[66:69] offset:28672
    ds_write_b128 v15, v[70:73] offset:29696
    ds_write_b128 v15, v[74:77] offset:30720
    ds_write_b128 v15, v[78:81] offset:31744
    s_waitcnt lgkmcnt(0)
    s_cmp_lg_u32 s91, 0
    s_cbranch_scc1 L_kv0_done
L_kvw_1:
    s_load_dwordx4 s[84:87], s[4:5], s3 glc
    s_waitcnt lgkmcnt(0)
    s_min_u32 s84, s84, s85
    s_min_u32 s84, s84, s86
    s_cmp_gt_u32 s84, 1
    s_cbranch_scc1 L_kv0
    s_sub_u32 s59, s59, 1
    s_cbranch_scc1 L_timeout
    s_sleep 1
    s_branch L_kvw_1
L_kv0:
    buffer_load_dwordx4 v[128:131], v6, s[4:7], s68 offen offset:0 sc1
    buffer_load_dwordx4 v[132:135], v6, s[4:7], s68 offen offset:512 sc1
    buffer_load_dwordx4 v[136:139], v10, s[4:7], s68 offen offset:2048 sc1
    buffer_load_dwordx4 v[140:143], v10, s[4:7], s68 offen offset:3072 sc1
L_kv0_done:
    s_add_u32 s68, s68, 32768
    v_mov_b32 v16, 0x3e0293ee
    v_bfe_u32 v122, v0, 7, 1
    v_bfe_u32 v123, v0, 8, 2
    v_lshl_add_u32 v122, v122, 2, v123
    v_bfe_u32 v123, v0, 4, 3
    v_lshlrev_b32 v123, 3, v123
    v_lshl_add_u32 v122, v122, 11, v123
    s_lshl_b32 s55, s52, 15
    s_lshl_b32 s56, s53, 6
    s_add_u32 s55, s55, s56
    v_add_u32 v17, s55, v122
    s_cmp_lg_u32 s89, 0
    s_cbranch_scc1 L_head_slow
    s_waitcnt vmcnt(0)
    v_mov_b64 v[106:107], v[128:129]
    v_mov_b64 v[108:109], v[130:131]
    v_mov_b64 v[110:111], v[132:133]
    v_mov_b64 v[112:113], v[134:135]
    v_mov_b64 v[114:115], v[136:137]
    v_mov_b64 v[116:117], v[138:139]
    v_mov_b64 v[118:119], v[140:141]
    v_mov_b64 v[120:121], v[142:143]
    ds_read_b128 v[50:53], v11 offset:8192
    ds_read_b128 v[54:57], v11 offset:12288
    ds_read_b128 v[58:61], v11 offset:16384
    ds_read_b128 v[62:65], v11 offset:20480
    ds_read_b128 v[66:69], v15 offset:8192
    ds_read_b128 v[70:73], v15 offset:9216
    ds_read_b128 v[74:77], v15 offset:10240
    ds_read_b128 v[78:81], v15 offset:11264
    v_mov_b64 v[82:83], 0
    v_mov_b64 v[84:85], 0
    v_mov_b64 v[86:87], 0
    v_mov_b64 v[88:89], 0
    v_mov_b64 v[90:91], 0
    v_mov_b64 v[92:93], 0
    v_mov_b64 v[94:95], 0
    v_mov_b64 v[96:97], 0
    v_mov_b64 v[98:99], 0
    v_mov_b64 v[100:101], 0
    v_mov_b64 v[102:103], 0
    v_mov_b64 v[104:105], 0
    s_waitcnt lgkmcnt(0)
    s_mov_b32 s82, -1
    s_lshl_b32 s77, s52, 10
    s_mov_b32 s79, 0
    s_mov_b32 s100, 0
    s_mov_b32 s101, 0
.p2align 6
    s_nop 0
    s_nop 0
L_hf_loop:
    s_waitcnt vmcnt(3)
    v_max3_u32 v122, v18, v19, v20
    v_max_u32 v122, v122, v21
    v_smfmac_f32_16x16x64_bf16 v[82:85], v[18:21], v[50:57], v2
    ds_write_b128 v11, v[18:21] offset:0
    s_waitcnt vmcnt(2)
    v_max3_u32 v122, v122, v34, v35
    v_max3_u32 v122, v122, v36, v37
    v_smfmac_f32_16x16x64_bf16 v[86:89], v[18:21], v[58:65], v2
    ds_write_b128 v11, v[34:37] offset:4096
    v_cmp_eq_u32 vcc, -1, v122
L_hf_ref:
    v_smfmac_f32_16x16x64_bf16 v[82:85], v[34:37], v[66:73], v2
    v_smfmac_f32_16x16x64_bf16 v[86:89], v[34:37], v[74:81], v2
    s_cbranch_vccnz L_hf_p1retry
    v_smfmac_f32_16x16x64_bf16 v[98:101], v[18:21], a[64:71], v2
    s_waitcnt lgkmcnt(0)
    s_barrier
    ds_read_b128 v[26:29], v13 offset:0
    buffer_load_dwordx4 v[128:131], v6, s[4:7], s68 offen offset:0 sc1
    v_smfmac_f32_16x16x64_bf16 v[102:105], v[18:21], a[72:79], v2
    ds_read_b128 v[22:25], v12 offset:0
    ds_read_b128 v[38:41], v12 offset:4096
    v_smfmac_f32_16x16x64_bf16 v[94:97], v[18:21], v[232:239], v2
    v_smfmac_f32_16x16x64_bf16 v[98:101], v[34:37], a[128:135], v2
    ds_read_b128 v[42:45], v13 offset:4096
    v_smfmac_f32_16x16x64_bf16 v[90:93], v[18:21], v[224:231], v2
    v_smfmac_f32_16x16x64_bf16 v[102:105], v[34:37], a[136:143], v2
    ds_read_b128 v[50:53], v15 offset:12288
    ds_read_b128 v[30:33], v14 offset:0
    s_waitcnt lgkmcnt(4)
    v_smfmac_f32_16x16x64_bf16 v[82:85], v[22:25], v[144:151], v2
    ds_read_b128 v[54:57], v15 offset:13312
    v_smfmac_f32_16x16x64_bf16 v[86:89], v[22:25], v[152:159], v2
    buffer_load_dwordx4 v[132:135], v6, s[4:7], s68 offen offset:512 sc1
    v_smfmac_f32_16x16x64_bf16 v[82:85], v[26:29], v[160:167], v2
    ds_read_b128 v[46:49], v14 offset:4096
    ds_read_b128 v[58:61], v15 offset:14336
    v_smfmac_f32_16x16x64_bf16 v[86:89], v[26:29], v[168:175], v2
    ds_read_b128 v[62:65], v15 offset:15360
    s_waitcnt lgkmcnt(6)
    v_smfmac_f32_16x16x64_bf16 v[86:89], v[38:41], v[200:207], v2
    ds_read_b128 v[66:69], v15 offset:0
    s_waitcnt lgkmcnt(5)
    v_smfmac_f32_16x16x64_bf16 v[86:89], v[30:33], v[184:191], v2
    buffer_load_dwordx4 v[136:139], v10, s[4:7], s68 offen offset:2048 sc1
    v_smfmac_f32_16x16x64_bf16 v[82:85], v[30:33], v[176:183], v2
    ds_read_b128 v[74:77], v15 offset:2048
    ds_read_b128 v[70:73], v15 offset:1024
    v_smfmac_f32_16x16x64_bf16 v[82:85], v[38:41], v[192:199], v2
    s_waitcnt lgkmcnt(5)
    v_smfmac_f32_16x16x64_bf16 v[82:85], v[42:45], v[50:57], v2
    buffer_load_dwordx4 v[140:143], v10, s[4:7], s68 offen offset:3072 sc1
    v_smfmac_f32_16x16x64_bf16 v[82:85], v[46:49], v[208:215], v2
    s_waitcnt lgkmcnt(3)
    v_smfmac_f32_16x16x64_bf16 v[86:89], v[42:45], v[58:65], v2
    ds_read_b128 v[54:57], v15 offset:5120
    ds_read_b128 v[78:81], v15 offset:3072
    v_smfmac_f32_16x16x64_bf16 v[86:89], v[46:49], v[216:223], v2
    v_add_f32 v82, v82, v83
    v_smfmac_f32_16x16x64_bf16 v[90:93], v[38:41], a[16:23], v2
    buffer_store_dwordx4 v[124:127], v10, s[4:7], s76 offen sc1
    ds_read_b128 v[50:53], v15 offset:4096
    ds_read_b128 v[58:61], v15 offset:6144
    v_add_f32 v84, v84, v85
    v_smfmac_f32_16x16x64_bf16 v[94:97], v[34:37], a[8:15], v2
    ds_read_b128 v[62:65], v15 offset:7168
    v_add_f32 v88, v88, v89
    v_smfmac_f32_16x16x64_bf16 v[90:93], v[30:33], v[240:247], v2
    v_cvt_pk_bf16_f32 v83, v84, v88
    v_add_f32 v86, v86, v87
    v_cvt_pk_bf16_f32 v82, v82, v86
    v_smfmac_f32_16x16x64_bf16 v[90:93], v[34:37], a[0:7], v2
    ds_write2_b32 v4, v82, v83 offset0:0 offset1:136
    s_waitcnt lgkmcnt(1)
    v_smfmac_f32_16x16x64_bf16 v[94:97], v[26:29], v[58:65], v2
    v_smfmac_f32_16x16x64_bf16 v[90:93], v[22:25], v[66:73], v2
    v_smfmac_f32_16x16x64_bf16 v[94:97], v[42:45], a[40:47], v2
    s_waitcnt vmcnt(5) lgkmcnt(0)
    s_barrier
    ds_read_b128 v[82:85], v5
    v_smfmac_f32_16x16x64_bf16 v[94:97], v[22:25], v[74:81], v2
    ds_read_b128 v[34:37], v0 offset:30976
    v_smfmac_f32_16x16x64_bf16 v[90:93], v[26:29], v[50:57], v2
    ds_read_b128 v[86:89], v5 offset:64
    v_smfmac_f32_16x16x64_bf16 v[94:97], v[38:41], a[24:31], v2
    ds_read_b128 v[50:53], v15 offset:24576
    v_smfmac_f32_16x16x64_bf16 v[90:93], v[42:45], a[32:39], v2
    ds_read_b128 v[54:57], v15 offset:25600
    s_waitcnt lgkmcnt(4)
    v_mfma_f32_16x16x32_bf16 v[124:127], v[106:109], v[82:85], 0
    ds_read_b128 v[58:61], v15 offset:26624
    s_waitcnt lgkmcnt(3)
    v_mfma_f32_16x16x32_bf16 v[124:127], v[110:113], v[86:89], v[124:127]
    ds_read_b128 v[70:73], v15 offset:29696
    ds_read_b128 v[62:65], v15 offset:27648
    v_smfmac_f32_16x16x64_bf16 v[94:97], v[30:33], v[248:255], v2
    ds_read_b128 v[18:21], v0 offset:29952
    ds_read_b128 v[74:77], v15 offset:30720
    v_smfmac_f32_16x16x64_bf16 v[90:93], v[46:49], a[48:55], v2
    v_add_f32_dpp v122, v125, v124 quad_perm:[1,0,3,2] row_mask:0xf bank_mask:0xf
    v_add_f32_dpp v123, v127, v126 quad_perm:[1,0,3,2] row_mask:0xf bank_mask:0xf
    v_smfmac_f32_16x16x64_bf16 v[94:97], v[46:49], a[56:63], v2
    ds_read_b128 v[78:81], v15 offset:31744
    v_exp_f32 v123, v123
    v_exp_f32 v122, v122
    v_smfmac_f32_16x16x64_bf16 v[98:101], v[22:25], a[80:87], v2
    ds_read_b128 v[66:69], v15 offset:28672
    v_cvt_pk_bf16_f32 v122, v122, v123
    v_smfmac_f32_16x16x64_bf16 v[102:105], v[30:33], a[120:127], v2
    ds_write_b32 v1, v122
    v_add_f32 v92, v92, v93
    v_add_f32 v94, v94, v95
    v_add_f32 v90, v90, v91
    v_add_f32 v96, v96, v97
    v_cvt_pk_bf16_f32 v90, v90, v94
    v_cvt_pk_bf16_f32 v91, v92, v96
    v_smfmac_f32_16x16x64_bf16 v[98:101], v[26:29], a[96:103], v2
    ds_write2_b32 v4, v90, v91 offset0:64 offset1:200
    v_smfmac_f32_16x16x64_bf16 v[102:105], v[22:25], a[88:95], v2
    v_smfmac_f32_16x16x64_bf16 v[102:105], v[38:41], a[152:159], v2
    v_smfmac_f32_16x16x64_bf16 v[98:101], v[38:41], a[144:151], v2
    v_smfmac_f32_16x16x64_bf16 v[98:101], v[30:33], a[112:119], v2
    s_waitcnt lgkmcnt(0)
    s_barrier
    v_smfmac_f32_16x16x64_bf16 v[98:101], v[42:45], v[50:57], v2
    ds_read_b128 v[90:93], v5 offset:256
    v_smfmac_f32_16x16x64_bf16 v[102:105], v[26:29], a[104:111], v2
    s_sub_u32 s76, s68, s78
    ds_read2st64_b32 v[106:107], v3 offset0:0 offset1:1
    v_smfmac_f32_16x16x64_bf16 v[98:101], v[46:49], v[66:73], v2
    ds_read_b128 v[94:97], v5 offset:320
    v_smfmac_f32_16x16x64_bf16 v[102:105], v[42:45], v[58:65], v2
    ds_read2st64_b32 v[108:109], v3 offset0:2 offset1:3
    s_waitcnt lgkmcnt(3)
    v_mfma_f32_16x16x32_bf16 v[30:33], v[90:93], v[82:85], 0
    v_smfmac_f32_16x16x64_bf16 v[102:105], v[46:49], v[74:81], v2
    ds_read_b128 v[38:41], v0 offset:30976
    s_waitcnt lgkmcnt(2)
    v_mfma_f32_16x16x32_bf16 v[30:33], v[94:97], v[86:89], v[30:33]
    v_add_f32 v100, v100, v101
    s_waitcnt lgkmcnt(1)
    v_mfma_f32_16x16x32_bf16 v[26:29], v[118:121], v[106:109], 0
    v_add_f32 v98, v98, v99
    v_mfma_f32_16x16x32_bf16 v[22:25], v[114:117], v[106:109], 0
    v_mul_f32_dpp v83, v32, v16 quad_perm:[0,0,2,2] row_mask:0xf bank_mask:0xf
    v_mul_f32_dpp v82, v30, v16 quad_perm:[0,0,2,2] row_mask:0xf bank_mask:0xf
    v_mfma_f32_16x16x32_bf16 v[110:113], v[18:21], v[106:109], 0
    v_fmac_f32_dpp v83, v33, v16 quad_perm:[1,1,3,3] row_mask:0xf bank_mask:0xf
    v_fmac_f32_dpp v82, v31, v16 quad_perm:[1,1,3,3] row_mask:0xf bank_mask:0xf
    v_exp_f32 v122, v82
    v_exp_f32 v123, v83
    v_add_f32 v104, v104, v105
    v_cvt_pk_bf16_f32 v34, v122, v123
    s_waitcnt lgkmcnt(0)
    v_cvt_pk_bf16_f32 v38, v98, v100
    v_mfma_f32_16x16x16_bf16 v[110:113], v[18:19], v[34:35], v[110:113]
    v_add_f32 v102, v102, v103
    v_cvt_pk_bf16_f32 v40, v102, v104
    v_mfma_f32_16x16x16_bf16 v[22:25], v[38:39], v[34:35], v[22:25]
    v_mfma_f32_16x16x16_bf16 v[26:29], v[40:41], v[34:35], v[26:29]
    v_rcp_f32 v110, v110
    s_nop 0
    v_cndmask_b32 v113, 0, v110, s[72:73]
    v_cndmask_b32 v112, v110, 0, s[72:73]
    v_mul_f32 v98, v22, v112
    v_mul_f32 v99, v23, v112
    v_mul_f32 v100, v24, v112
    v_mul_f32 v101, v25, v112
    v_pk_fma_f32 v[100:101], v[28:29], v[112:113], v[100:101] op_sel:[0,1,0] op_sel_hi:[1,1,1]
    v_pk_fma_f32 v[98:99], v[26:27], v[112:113], v[98:99] op_sel:[0,1,0] op_sel_hi:[1,1,1]
    v_cvt_pk_bf16_f32 v102, v98, v99
    v_cvt_pk_bf16_f32 v103, v100, v101
    ds_write_b64 v9, v[102:103]
    v_mfma_f32_16x16x16_bf16 v[46:49], v[36:37], v[36:37], 0
    s_cmp_eq_u32 s67, 63
    s_cbranch_scc1 L_hf_done
    v_mfma_f32_16x16x16_bf16 v[42:45], v[36:37], v[36:37], 0
    v_max_f32 v111, v110, v111
    v_cmp_nge_f32 vcc, s75, v111
    v_mfma_f32_16x16x16_bf16 v[30:33], v[36:37], v[36:37], 0
    s_cbranch_vccnz L_hf_slow
L_hf_soft_ok:
    v_mfma_f32_16x16x16_bf16 v[22:25], v[36:37], v[36:37], 0
    s_waitcnt lgkmcnt(0)
    s_barrier
    ds_read_b128 v[90:93], v0 offset:4096
    ds_read_b128 v[94:97], v0 offset:5120
    v_mfma_f32_16x16x16_bf16 v[26:29], v[36:37], v[36:37], 0
    ds_write2_b32 v4, v38, v40 offset0:0 offset1:136
    v_mov_b32 v38, 0
    v_mov_b32 v34, 0
    v_mfma_f32_16x16x16_bf16 v[18:21], v[36:37], v[36:37], 0
    s_cmp_lg_u32 s69, 0
    s_waitcnt lgkmcnt(2)
    v_smfmac_f32_16x16x64_bf16 v[42:45], v[90:93], a[160:167], v2
    s_waitcnt lgkmcnt(1)
    v_smfmac_f32_16x16x64_bf16 v[42:45], v[94:97], a[208:215], v2
    ds_read_b128 v[50:53], v15 offset:16384
    v_mov_b32 v40, 0
    v_smfmac_f32_16x16x64_bf16 v[46:49], v[90:93], a[168:175], v2
    ds_read_b128 v[54:57], v15 offset:17408
    ds_read_b128 v[62:65], v15 offset:19456
    v_smfmac_f32_16x16x64_bf16 v[46:49], v[94:97], a[216:223], v2
    ds_read_b128 v[58:61], v15 offset:18432
    v_add_f32 v42, v42, v43
    v_smfmac_f32_16x16x64_bf16 v[30:33], v[90:93], a[176:183], v2
    v_add_f32 v44, v44, v45
    v_smfmac_f32_16x16x64_bf16 v[30:33], v[94:97], a[224:231], v2
    ds_read_b128 v[66:69], v15 offset:20480
    v_cvt_pk_bf16_f32 v98, v42, v44
    v_and_or_b32 v98, v98, -2, s71
    v_add_f32 v46, v46, v47
    v_smfmac_f32_16x16x64_bf16 v[22:25], v[90:93], a[184:191], v2
    ds_read_b128 v[70:73], v15 offset:21504
    v_add_f32 v48, v48, v49
    v_cvt_pk_bf16_f32 v99, v46, v48
    v_smfmac_f32_16x16x64_bf16 v[22:25], v[94:97], a[232:239], v2
    ds_read_b128 v[74:77], v15 offset:22528
    v_add_f32 v30, v30, v31
    v_smfmac_f32_16x16x64_bf16 v[26:29], v[90:93], a[192:199], v2
    ds_read_b128 v[78:81], v15 offset:23552
    v_add_f32 v32, v32, v33
    v_cvt_pk_bf16_f32 v100, v30, v32
    v_smfmac_f32_16x16x64_bf16 v[26:29], v[94:97], a[240:247], v2
    v_add_f32 v22, v22, v23
    v_add_f32 v24, v24, v25
    v_cvt_pk_bf16_f32 v101, v22, v24
    v_smfmac_f32_16x16x64_bf16 v[38:41], v[90:93], a[200:207], v2
    buffer_store_dwordx4 v[98:101], v7, s[4:7], s60 offen
    v_smfmac_f32_16x16x64_bf16 v[38:41], v[94:97], a[248:255], v2
    v_add_f32 v26, v26, v27
    s_waitcnt lgkmcnt(1)
    v_smfmac_f32_16x16x64_bf16 v[18:21], v[90:93], v[50:57], v2
    ds_read_b128 v[22:25], v0 offset:28928
    v_smfmac_f32_16x16x64_bf16 v[18:21], v[94:97], v[66:73], v2
    v_add_f32 v28, v28, v29
    v_cvt_pk_bf16_f32 v102, v26, v28
    v_and_or_b32 v102, v102, -2, s71
    v_add_f32 v38, v38, v39
    v_smfmac_f32_16x16x64_bf16 v[34:37], v[90:93], v[58:65], v2
    v_add_f32 v40, v40, v41
    v_cvt_pk_bf16_f32 v103, v38, v40
    s_waitcnt lgkmcnt(1)
    v_smfmac_f32_16x16x64_bf16 v[34:37], v[94:97], v[74:81], v2
    buffer_store_dwordx2 v[102:103], v17, s[4:7], s61 offen
    v_add_f32 v20, v20, v21
    v_add_f32 v18, v18, v19
    v_cvt_pk_bf16_f32 v104, v18, v20
    v_and_or_b32 v104, v104, -2, s71
    s_nop 2
    v_add_f32 v34, v34, v35
    v_add_f32 v36, v36, v37
    v_cvt_pk_bf16_f32 v105, v34, v36
    buffer_store_dwordx2 v[104:105], v17, s[4:7], s15 offen
L_hf_cend:
    ds_read_b128 v[50:53], v11 offset:8192
    ds_read_b128 v[54:57], v11 offset:12288
    ds_read_b128 v[58:61], v11 offset:16384
    ds_read_b128 v[62:65], v11 offset:20480
    ds_read_b128 v[66:69], v15 offset:8192
    ds_read_b128 v[70:73], v15 offset:9216
    ds_read_b128 v[74:77], v15 offset:10240
    ds_read_b128 v[78:81], v15 offset:11264
    s_cbranch_scc0 L_hf_rw0
    s_waitcnt vmcnt(3)
    v_mov_b64 v[106:107], v[128:129]
    v_mov_b64 v[108:109], v[130:131]
    s_xor_b32 s65, s65, 0x2000
    s_xor_b32 s66, s66, 0x2000
    s_add_u32 s67, s67, 1
    s_add_u32 s68, s68, 32768
    s_add_u32 s55, s67, 1
    s_min_u32 s55, s55, 63
    v_mov_b32 v123, -1
    s_waitcnt lgkmcnt(0)
    s_min_u32 s84, s84, s85
    s_min_u32 s84, s84, s86
    s_cmp_gt_u32 s84, s55
    s_cselect_b32 s83, 0, 1
    s_add_u32 s56, s55, 2
    s_min_u32 s56, s56, 63
    s_cmp_gt_u32 s84, s56
    s_cbranch_scc1 L_hf_nofla
    s_load_dwordx4 s[84:87], s[4:5], s3 glc
    s_branch L_hf_nospa
L_hf_nofla:
L_hf_nospa:
    s_nop 2
    s_cmp_lg_u32 s52, 3
    s_cbranch_scc1 L_hf_rw2
    s_nop 7
L_hf_rw2:
    buffer_load_dwordx4 v[38:41], v10, s[4:7], s62 offen sc1
    buffer_load_dwordx4 v[42:45], v10, s[4:7], s62 offen offset:1024 sc1
    s_nop 15
    s_nop 15
    s_nop 5
    buffer_load_dwordx4 v[26:29], v10, s[4:7], s62 offen sc1
    buffer_load_dwordx4 v[30:33], v10, s[4:7], s62 offen offset:1024 sc1
    s_branch L_hf_red0
L_hf_rw0:
    buffer_load_dwordx4 v[38:41], v10, s[4:7], s62 offen sc1
    buffer_load_dwordx4 v[42:45], v10, s[4:7], s62 offen offset:1024 sc1
    s_waitcnt vmcnt(5)
    v_mov_b64 v[106:107], v[128:129]
    v_mov_b64 v[108:109], v[130:131]
    s_xor_b32 s65, s65, 0x2000
    s_xor_b32 s66, s66, 0x2000
    s_add_u32 s67, s67, 1
    s_add_u32 s68, s68, 32768
    s_add_u32 s55, s67, 1
    s_min_u32 s55, s55, 63
    v_mov_b32 v123, -1
    s_waitcnt lgkmcnt(0)
    s_min_u32 s84, s84, s85
    s_min_u32 s84, s84, s86
    s_cmp_gt_u32 s84, s55
    s_cselect_b32 s83, 0, 1
    s_add_u32 s56, s55, 2
    s_min_u32 s56, s56, 63
    s_cmp_gt_u32 s84, s56
    s_cbranch_scc1 L_hf_noflb
    s_load_dwordx4 s[84:87], s[4:5], s3 glc
    s_branch L_hf_nospb
L_hf_noflb:
L_hf_nospb:
    s_nop 15
    s_nop 15
    buffer_load_dwordx4 v[26:29], v10, s[4:7], s62 offen sc1
    buffer_load_dwordx4 v[30:33], v10, s[4:7], s62 offen offset:1024 sc1
L_hf_red0:
    s_waitcnt vmcnt(3)
    v_mfma_f32_16x16x32_bf16 v[46:49], v[22:25], v[38:41], 0
    s_waitcnt vmcnt(2)
    v_mfma_f32_16x16x32_bf16 v[46:49], v[22:25], v[42:45], v[46:49]
    v_bitop3_b32 v122, v38, v42, s71 bitop3:0x7e
    v_bitop3_b32 v124, v40, v44, s71 bitop3:0x7e
    v_and_b32 v122, 1, v122
    v_and_or_b32 v122, v124, s14, v122
    v_cmp_ne_u32 vcc, 0, v122
    s_nop 2
    v_add_f32_dpp v46, v46, v46 row_ror:8 row_mask:0xf bank_mask:0xf
    v_add_f32_dpp v47, v47, v47 row_ror:8 row_mask:0xf bank_mask:0xf
    s_cbranch_vccnz L_hf_rretry0
    v_add_f32_dpp v46, v46, v46 row_ror:4 row_mask:0xf bank_mask:0xf
    v_add_f32_dpp v47, v47, v47 row_ror:4 row_mask:0xf bank_mask:0xf
    v_cvt_pk_bf16_f32 v48, v46, v47
    buffer_store_dword v48, v8, s[4:7], s63 offen
L_hf_rok:
    s_xor_b32 s63, s63, 0x2000
    buffer_store_dword v123, v8, s[4:7], s63 offen
    s_xor_b32 s71, s71, 1
    s_nop 15
    s_nop 6
    s_cmp_lg_u32 s83, 0
    s_cbranch_scc1 L_hf_kvchk
L_hf_kvok:
    s_barrier
    buffer_load_dwordx4 v[18:21], v10, s[4:7], s65 offen sc1
    s_nop 1
    buffer_load_dwordx4 v[34:37], v10, s[4:7], s66 offen sc1
    v_bfe_u32 v124, v0, 8, 2
    v_mul_u32_u24 v124, 288, v124
    v_add3_u32 v124, v124, v0, s13
    ds_read_b128 v[124:127], v124
    v_mov_b64 v[110:111], v[132:133]
    v_mov_b64 v[112:113], v[134:135]
    v_mov_b64 v[114:115], v[136:137]
    v_mov_b64 v[116:117], v[138:139]
    v_mov_b64 v[118:119], v[140:141]
    v_mov_b64 v[120:121], v[142:143]
    v_mov_b64 v[82:83], 0
    v_mov_b64 v[84:85], 0
    v_mov_b64 v[86:87], 0
    v_mov_b64 v[88:89], 0
    v_mov_b64 v[90:91], 0
    v_mov_b64 v[92:93], 0
    v_mov_b64 v[94:95], 0
    v_mov_b64 v[96:97], 0
    v_mov_b64 v[98:99], 0
    s_nop 0
    buffer_load_dwordx4 v[18:21], v10, s[4:7], s65 offen sc1
    buffer_load_dwordx4 v[34:37], v10, s[4:7], s66 offen sc1
    v_mov_b64 v[100:101], 0
    v_mov_b64 v[102:103], 0
    v_mov_b64 v[104:105], 0
    s_branch L_hf_loop
L_hf_p1retry:
    s_mov_b64 exec, vcc
    buffer_load_dwordx4 v[18:21], v10, s[4:7], s65 offen sc1
    buffer_load_dwordx4 v[34:37], v10, s[4:7], s66 offen sc1
    s_mov_b64 exec, -1
    v_mov_b64 v[82:83], 0
    v_mov_b64 v[84:85], 0
    s_nop 0
    v_mov_b64 v[86:87], 0
    v_mov_b64 v[88:89], 0
    v_mov_b64 v[98:99], 0
    v_mov_b64 v[100:101], 0
    v_mov_b64 v[102:103], 0
    v_mov_b64 v[104:105], 0
    s_add_u32 s79, s79, 1
    s_sub_u32 s59, s59, 1
    s_cbranch_scc1 L_timeout
    s_branch L_hf_loop
L_hf_kvchk:
    s_waitcnt lgkmcnt(0)
    s_min_u32 s84, s84, s85
    s_min_u32 s84, s84, s86
    s_cmp_gt_u32 s84, s55
    s_cbranch_scc1 L_hf_kvok
L_kvw_2:
    s_load_dwordx4 s[84:87], s[4:5], s3 glc
    s_waitcnt lgkmcnt(0)
    s_min_u32 s84, s84, s85
    s_min_u32 s84, s84, s86
    s_cmp_gt_u32 s84, s55
    s_cbranch_scc1 L_hf_kvok
    s_sub_u32 s59, s59, 1
    s_cbranch_scc1 L_timeout
    s_sleep 1
    s_branch L_kvw_2
L_hf_rretry0:
    buffer_load_dwordx4 v[38:41], v10, s[4:7], s62 offen sc1
    buffer_load_dwordx4 v[42:45], v10, s[4:7], s62 offen offset:1024 sc1
    s_add_u32 s101, s101, 1
    s_sub_u32 s59, s59, 1
    s_cbranch_scc1 L_timeout
L_hf_red1:
    s_waitcnt vmcnt(3)
    v_mfma_f32_16x16x32_bf16 v[46:49], v[22:25], v[26:29], 0
    s_waitcnt vmcnt(2)
    v_mfma_f32_16x16x32_bf16 v[46:49], v[22:25], v[30:33], v[46:49]
    v_bitop3_b32 v122, v26, v30, s71 bitop3:0x7e
    v_bitop3_b32 v124, v28, v32, s71 bitop3:0x7e
    v_and_b32 v122, 1, v122
    v_and_or_b32 v122, v124, s14, v122
    v_cmp_ne_u32 vcc, 0, v122
    s_nop 2
    v_add_f32_dpp v46, v46, v46 row_ror:8 row_mask:0xf bank_mask:0xf
    v_add_f32_dpp v47, v47, v47 row_ror:8 row_mask:0xf bank_mask:0xf
    s_cbranch_vccnz L_hf_rretry1
    v_add_f32_dpp v46, v46, v46 row_ror:4 row_mask:0xf bank_mask:0xf
    v_add_f32_dpp v47, v47, v47 row_ror:4 row_mask:0xf bank_mask:0xf
    v_cvt_pk_bf16_f32 v48, v46, v47
    buffer_store_dword v48, v8, s[4:7], s63 offen
    s_branch L_hf_rok
L_hf_rretry1:
    buffer_load_dwordx4 v[26:29], v10, s[4:7], s62 offen sc1
    buffer_load_dwordx4 v[30:33], v10, s[4:7], s62 offen offset:1024 sc1
    s_add_u32 s101, s101, 1
    s_sub_u32 s59, s59, 1
    s_cbranch_scc1 L_timeout
    s_branch L_hf_red0
L_hf_slow:
    v_mov_b32_dpp v98, v124 quad_perm:[0,0,2,2] row_mask:0xf bank_mask:0xf
    v_mov_b32_dpp v99, v126 quad_perm:[0,0,2,2] row_mask:0xf bank_mask:0xf
    s_nop 0
    v_add_f32_dpp v98, v125, v98 quad_perm:[1,1,3,3] row_mask:0xf bank_mask:0xf
    v_add_f32_dpp v99, v127, v99 quad_perm:[1,1,3,3] row_mask:0xf bank_mask:0xf
    v_max3_f32 v122, v98, v99, v82
    v_max_f32 v122, v122, v83
    v_mov_b32 v123, v122
    s_nop 1
    v_permlane16_swap_b32 v122, v123
    v_max_f32 v122, v122, v123
    v_mov_b32 v123, v122
    s_nop 1
    v_permlane32_swap_b32 v122, v123
    v_max_f32 v122, v122, v123
    ds_write_b32 v1, v122 offset:1024
    s_waitcnt lgkmcnt(0)
    s_barrier
    ds_read2st64_b32 v[106:107], v3 offset0:4 offset1:5
    ds_read2st64_b32 v[108:109], v3 offset0:6 offset1:7
    s_waitcnt lgkmcnt(0)
    v_max3_f32 v122, v106, v107, v108
    v_max_f32 v122, v122, v109
    v_sub_f32 v98, v98, v122
    v_sub_f32 v99, v99, v122
    v_sub_f32 v82, v82, v122
    v_sub_f32 v83, v83, v122
    v_exp_f32 v98, v98
    v_exp_f32 v99, v99
    v_exp_f32 v82, v82
    v_exp_f32 v83, v83
    v_cvt_pk_bf16_f32 v122, v98, v99
    ds_write_b32 v1, v122 offset:0
    v_cvt_pk_bf16_f32 v34, v82, v83
    s_waitcnt lgkmcnt(0)
    s_barrier
    ds_read2st64_b32 v[106:107], v3 offset0:0 offset1:1
    ds_read2st64_b32 v[108:109], v3 offset0:2 offset1:3
    s_waitcnt lgkmcnt(0)
    v_mfma_f32_16x16x32_bf16 v[110:113], v[18:21], v[106:109], 0
    v_mfma_f32_16x16x32_bf16 v[22:25], v[114:117], v[106:109], 0
    v_mfma_f32_16x16x32_bf16 v[26:29], v[118:121], v[106:109], 0
    v_mfma_f32_16x16x16_bf16 v[110:113], v[18:19], v[34:35], v[110:113]
    v_mfma_f32_16x16x16_bf16 v[22:25], v[38:39], v[34:35], v[22:25]
    v_mfma_f32_16x16x16_bf16 v[26:29], v[40:41], v[34:35], v[26:29]
    v_rcp_f32 v110, v110
    s_nop 0
    v_cndmask_b32 v112, v110, 0, s[72:73]
    v_cndmask_b32 v113, 0, v110, s[72:73]
    v_mul_f32 v98, v22, v112
    v_mul_f32 v99, v23, v112
    v_mul_f32 v100, v24, v112
    v_mul_f32 v101, v25, v112
    v_pk_fma_f32 v[98:99], v[26:27], v[112:113], v[98:99] op_sel:[0,1,0] op_sel_hi:[1,1,1]
    v_pk_fma_f32 v[100:101], v[28:29], v[112:113], v[100:101] op_sel:[0,1,0] op_sel_hi:[1,1,1]
    v_cvt_pk_bf16_f32 v102, v98, v99
    v_cvt_pk_bf16_f32 v103, v100, v101
    ds_write_b64 v9, v[102:103]
    s_branch L_hf_soft_ok
L_hf_done:
    ds_write2_b32 v4, v38, v40 offset0:0 offset1:136
    s_waitcnt lgkmcnt(0)
    s_barrier
    v_bfe_u32 v124, v0, 8, 2
    v_mul_u32_u24 v124, 288, v124
    v_add3_u32 v124, v124, v0, s13
    ds_read_b128 v[124:127], v124
    s_waitcnt lgkmcnt(0)
    buffer_store_dwordx4 v[124:127], v10, s[4:7], s76 offen sc1
    s_waitcnt vmcnt(0)
    s_branch L_end
L_head_slow:
    s_waitcnt vmcnt(0)
    v_mov_b64 v[106:107], v[128:129]
    v_mov_b64 v[108:109], v[130:131]
    v_mov_b64 v[110:111], v[132:133]
    v_mov_b64 v[112:113], v[134:135]
    v_mov_b64 v[114:115], v[136:137]
    v_mov_b64 v[116:117], v[138:139]
    v_mov_b64 v[118:119], v[140:141]
    v_mov_b64 v[120:121], v[142:143]
    ds_read_b128 v[50:53], v11 offset:8192
    ds_read_b128 v[54:57], v11 offset:12288
    ds_read_b128 v[58:61], v11 offset:16384
    ds_read_b128 v[62:65], v11 offset:20480
    ds_read_b128 v[66:69], v15 offset:8192
    ds_read_b128 v[70:73], v15 offset:9216
    ds_read_b128 v[74:77], v15 offset:10240
    ds_read_b128 v[78:81], v15 offset:11264
    v_mov_b64 v[82:83], 0
    v_mov_b64 v[84:85], 0
    v_mov_b64 v[86:87], 0
    v_mov_b64 v[88:89], 0
    v_mov_b64 v[90:91], 0
    v_mov_b64 v[92:93], 0
    v_mov_b64 v[94:95], 0
    v_mov_b64 v[96:97], 0
    v_mov_b64 v[98:99], 0
    v_mov_b64 v[100:101], 0
    v_mov_b64 v[102:103], 0
    v_mov_b64 v[104:105], 0
    s_waitcnt lgkmcnt(0)
    s_mov_b32 s82, -1
    s_lshl_b32 s77, s52, 10
    s_mov_b32 s79, 0
    s_mov_b32 s100, 0
    s_mov_b32 s101, 0
.p2align 6
    s_nop 0
    s_nop 0
L_hs_loop:
    s_waitcnt vmcnt(3)
    v_max3_u32 v122, v18, v19, v20
    v_max_u32 v122, v122, v21
    v_smfmac_f32_16x16x64_bf16 v[82:85], v[18:21], v[50:57], v2
    ds_write_b128 v11, v[18:21] offset:0
    s_waitcnt vmcnt(2)
    v_max3_u32 v122, v122, v34, v35
    v_max3_u32 v122, v122, v36, v37
    v_smfmac_f32_16x16x64_bf16 v[86:89], v[18:21], v[58:65], v2
    ds_write_b128 v11, v[34:37] offset:4096
    v_cmp_eq_u32 vcc, -1, v122
L_hs_ref:
    v_smfmac_f32_16x16x64_bf16 v[82:85], v[34:37], v[66:73], v2
    v_smfmac_f32_16x16x64_bf16 v[86:89], v[34:37], v[74:81], v2
    s_cbranch_vccnz L_hs_p1retry
    v_smfmac_f32_16x16x64_bf16 v[98:101], v[18:21], a[64:71], v2
    s_waitcnt lgkmcnt(0)
    s_barrier
    ds_read_b128 v[26:29], v13 offset:0
    buffer_load_dwordx4 v[128:131], v6, s[4:7], s68 offen offset:0 sc1
    v_smfmac_f32_16x16x64_bf16 v[102:105], v[18:21], a[72:79], v2
    ds_read_b128 v[22:25], v12 offset:0
    ds_read_b128 v[38:41], v12 offset:4096
    v_smfmac_f32_16x16x64_bf16 v[94:97], v[18:21], v[232:239], v2
    v_smfmac_f32_16x16x64_bf16 v[98:101], v[34:37], a[128:135], v2
    ds_read_b128 v[42:45], v13 offset:4096
    v_smfmac_f32_16x16x64_bf16 v[90:93], v[18:21], v[224:231], v2
    v_smfmac_f32_16x16x64_bf16 v[102:105], v[34:37], a[136:143], v2
    ds_read_b128 v[50:53], v15 offset:12288
    ds_read_b128 v[30:33], v14 offset:0
    s_waitcnt lgkmcnt(4)
    v_smfmac_f32_16x16x64_bf16 v[82:85], v[22:25], v[144:151], v2
    ds_read_b128 v[54:57], v15 offset:13312
    v_smfmac_f32_16x16x64_bf16 v[86:89], v[22:25], v[152:159], v2
    buffer_load_dwordx4 v[132:135], v6, s[4:7], s68 offen offset:512 sc1
    v_smfmac_f32_16x16x64_bf16 v[82:85], v[26:29], v[160:167], v2
    ds_read_b128 v[46:49], v14 offset:4096
    ds_read_b128 v[58:61], v15 offset:14336
    v_smfmac_f32_16x16x64_bf16 v[86:89], v[26:29], v[168:175], v2
    ds_read_b128 v[62:65], v15 offset:15360
    s_waitcnt lgkmcnt(6)
    v_smfmac_f32_16x16x64_bf16 v[86:89], v[38:41], v[200:207], v2
    ds_read_b128 v[66:69], v15 offset:0
    s_waitcnt lgkmcnt(5)
    v_smfmac_f32_16x16x64_bf16 v[86:89], v[30:33], v[184:191], v2
    buffer_load_dwordx4 v[136:139], v10, s[4:7], s68 offen offset:2048 sc1
    v_smfmac_f32_16x16x64_bf16 v[82:85], v[30:33], v[176:183], v2
    ds_read_b128 v[74:77], v15 offset:2048
    ds_read_b128 v[70:73], v15 offset:1024
    v_smfmac_f32_16x16x64_bf16 v[82:85], v[38:41], v[192:199], v2
    s_waitcnt lgkmcnt(5)
    v_smfmac_f32_16x16x64_bf16 v[82:85], v[42:45], v[50:57], v2
    buffer_load_dwordx4 v[140:143], v10, s[4:7], s68 offen offset:3072 sc1
    v_smfmac_f32_16x16x64_bf16 v[82:85], v[46:49], v[208:215], v2
    s_waitcnt lgkmcnt(3)
    v_smfmac_f32_16x16x64_bf16 v[86:89], v[42:45], v[58:65], v2
    ds_read_b128 v[54:57], v15 offset:5120
    ds_read_b128 v[78:81], v15 offset:3072
    v_smfmac_f32_16x16x64_bf16 v[86:89], v[46:49], v[216:223], v2
    v_add_f32 v82, v82, v83
    v_smfmac_f32_16x16x64_bf16 v[90:93], v[38:41], a[16:23], v2
    buffer_store_dwordx4 v[124:127], v10, s[4:7], s76 offen sc1
    ds_read_b128 v[50:53], v15 offset:4096
    ds_read_b128 v[58:61], v15 offset:6144
    v_add_f32 v84, v84, v85
    v_smfmac_f32_16x16x64_bf16 v[94:97], v[34:37], a[8:15], v2
    ds_read_b128 v[62:65], v15 offset:7168
    v_add_f32 v88, v88, v89
    v_smfmac_f32_16x16x64_bf16 v[90:93], v[30:33], v[240:247], v2
    v_cvt_pk_bf16_f32 v83, v84, v88
    v_add_f32 v86, v86, v87
    v_cvt_pk_bf16_f32 v82, v82, v86
    v_smfmac_f32_16x16x64_bf16 v[90:93], v[34:37], a[0:7], v2
    ds_write2_b32 v4, v82, v83 offset0:0 offset1:136
    s_waitcnt lgkmcnt(1)
    v_smfmac_f32_16x16x64_bf16 v[94:97], v[26:29], v[58:65], v2
    v_smfmac_f32_16x16x64_bf16 v[90:93], v[22:25], v[66:73], v2
    v_smfmac_f32_16x16x64_bf16 v[94:97], v[42:45], a[40:47], v2
    s_waitcnt vmcnt(5) lgkmcnt(0)
    s_barrier
    ds_read_b128 v[82:85], v5
    v_smfmac_f32_16x16x64_bf16 v[94:97], v[22:25], v[74:81], v2
    ds_read_b128 v[34:37], v0 offset:30976
    v_smfmac_f32_16x16x64_bf16 v[90:93], v[26:29], v[50:57], v2
    ds_read_b128 v[86:89], v5 offset:64
    v_smfmac_f32_16x16x64_bf16 v[94:97], v[38:41], a[24:31], v2
    ds_read_b128 v[50:53], v15 offset:24576
    v_smfmac_f32_16x16x64_bf16 v[90:93], v[42:45], a[32:39], v2
    ds_read_b128 v[54:57], v15 offset:25600
    s_waitcnt lgkmcnt(4)
    v_mfma_f32_16x16x32_bf16 v[124:127], v[106:109], v[82:85], 0
    ds_read_b128 v[58:61], v15 offset:26624
    s_waitcnt lgkmcnt(3)
    v_mfma_f32_16x16x32_bf16 v[124:127], v[110:113], v[86:89], v[124:127]
    ds_read_b128 v[70:73], v15 offset:29696
    ds_read_b128 v[62:65], v15 offset:27648
    v_smfmac_f32_16x16x64_bf16 v[94:97], v[30:33], v[248:255], v2
    ds_read_b128 v[18:21], v0 offset:29952
    ds_read_b128 v[74:77], v15 offset:30720
    v_smfmac_f32_16x16x64_bf16 v[90:93], v[46:49], a[48:55], v2
    v_add_f32_dpp v122, v125, v124 quad_perm:[1,0,3,2] row_mask:0xf bank_mask:0xf
    v_add_f32_dpp v123, v127, v126 quad_perm:[1,0,3,2] row_mask:0xf bank_mask:0xf
    v_smfmac_f32_16x16x64_bf16 v[94:97], v[46:49], a[56:63], v2
    ds_read_b128 v[78:81], v15 offset:31744
    v_exp_f32 v123, v123
    v_exp_f32 v122, v122
    v_smfmac_f32_16x16x64_bf16 v[98:101], v[22:25], a[80:87], v2
    ds_read_b128 v[66:69], v15 offset:28672
    v_cvt_pk_bf16_f32 v122, v122, v123
    v_smfmac_f32_16x16x64_bf16 v[102:105], v[30:33], a[120:127], v2
    ds_write_b32 v1, v122
    v_add_f32 v92, v92, v93
    v_add_f32 v94, v94, v95
    v_add_f32 v90, v90, v91
    v_add_f32 v96, v96, v97
    v_cvt_pk_bf16_f32 v90, v90, v94
    v_cvt_pk_bf16_f32 v91, v92, v96
    v_smfmac_f32_16x16x64_bf16 v[98:101], v[26:29], a[96:103], v2
    ds_write2_b32 v4, v90, v91 offset0:64 offset1:200
    v_smfmac_f32_16x16x64_bf16 v[102:105], v[22:25], a[88:95], v2
    v_smfmac_f32_16x16x64_bf16 v[102:105], v[38:41], a[152:159], v2
    v_smfmac_f32_16x16x64_bf16 v[98:101], v[38:41], a[144:151], v2
    v_smfmac_f32_16x16x64_bf16 v[98:101], v[30:33], a[112:119], v2
    s_waitcnt lgkmcnt(0)
    s_barrier
    v_smfmac_f32_16x16x64_bf16 v[98:101], v[42:45], v[50:57], v2
    ds_read_b128 v[90:93], v5 offset:256
    v_smfmac_f32_16x16x64_bf16 v[102:105], v[26:29], a[104:111], v2
    s_sub_u32 s76, s68, s78
    ds_read2st64_b32 v[106:107], v3 offset0:0 offset1:1
    v_smfmac_f32_16x16x64_bf16 v[98:101], v[46:49], v[66:73], v2
    ds_read_b128 v[94:97], v5 offset:320
    v_smfmac_f32_16x16x64_bf16 v[102:105], v[42:45], v[58:65], v2
    ds_read2st64_b32 v[108:109], v3 offset0:2 offset1:3
    s_waitcnt lgkmcnt(3)
    v_mfma_f32_16x16x32_bf16 v[30:33], v[90:93], v[82:85], 0
    v_smfmac_f32_16x16x64_bf16 v[102:105], v[46:49], v[74:81], v2
    ds_read_b128 v[38:41], v0 offset:30976
    s_waitcnt lgkmcnt(2)
    v_mfma_f32_16x16x32_bf16 v[30:33], v[94:97], v[86:89], v[30:33]
    v_add_f32 v100, v100, v101
    s_waitcnt lgkmcnt(1)
    v_mfma_f32_16x16x32_bf16 v[26:29], v[118:121], v[106:109], 0
    v_add_f32 v98, v98, v99
    v_mfma_f32_16x16x32_bf16 v[22:25], v[114:117], v[106:109], 0
    v_mul_f32_dpp v83, v32, v16 quad_perm:[0,0,2,2] row_mask:0xf bank_mask:0xf
    v_mul_f32_dpp v82, v30, v16 quad_perm:[0,0,2,2] row_mask:0xf bank_mask:0xf
    v_mfma_f32_16x16x32_bf16 v[110:113], v[18:21], v[106:109], 0
    v_fmac_f32_dpp v83, v33, v16 quad_perm:[1,1,3,3] row_mask:0xf bank_mask:0xf
    v_fmac_f32_dpp v82, v31, v16 quad_perm:[1,1,3,3] row_mask:0xf bank_mask:0xf
    v_exp_f32 v122, v82
    v_exp_f32 v123, v83
    v_add_f32 v104, v104, v105
    v_cvt_pk_bf16_f32 v34, v122, v123
    s_waitcnt lgkmcnt(0)
    v_cvt_pk_bf16_f32 v38, v98, v100
    v_mfma_f32_16x16x16_bf16 v[110:113], v[18:19], v[34:35], v[110:113]
    v_add_f32 v102, v102, v103
    v_cvt_pk_bf16_f32 v40, v102, v104
    v_mfma_f32_16x16x16_bf16 v[22:25], v[38:39], v[34:35], v[22:25]
    v_mfma_f32_16x16x16_bf16 v[26:29], v[40:41], v[34:35], v[26:29]
    v_rcp_f32 v110, v110
    s_nop 0
    v_cndmask_b32 v113, 0, v110, s[72:73]
    v_cndmask_b32 v112, v110, 0, s[72:73]
    v_mul_f32 v98, v22, v112
    v_mul_f32 v99, v23, v112
    v_mul_f32 v100, v24, v112
    v_mul_f32 v101, v25, v112
    v_pk_fma_f32 v[100:101], v[28:29], v[112:113], v[100:101] op_sel:[0,1,0] op_sel_hi:[1,1,1]
    v_pk_fma_f32 v[98:99], v[26:27], v[112:113], v[98:99] op_sel:[0,1,0] op_sel_hi:[1,1,1]
    v_cvt_pk_bf16_f32 v102, v98, v99
    v_cvt_pk_bf16_f32 v103, v100, v101
    ds_write_b64 v9, v[102:103]
    v_mfma_f32_16x16x16_bf16 v[46:49], v[36:37], v[36:37], 0
    s_cmp_eq_u32 s67, 63
    s_cbranch_scc1 L_hs_done
    v_mfma_f32_16x16x16_bf16 v[42:45], v[36:37], v[36:37], 0
    v_max_f32 v111, v110, v111
    v_cmp_nge_f32 vcc, s75, v111
    v_mfma_f32_16x16x16_bf16 v[30:33], v[36:37], v[36:37], 0
    s_cbranch_vccnz L_hs_slow
L_hs_soft_ok:
    v_mfma_f32_16x16x16_bf16 v[22:25], v[36:37], v[36:37], 0
    s_waitcnt lgkmcnt(0)
    s_barrier
    ds_read_b128 v[90:93], v0 offset:4096
    ds_read_b128 v[94:97], v0 offset:5120
    v_mfma_f32_16x16x16_bf16 v[26:29], v[36:37], v[36:37], 0
    ds_write2_b32 v4, v38, v40 offset0:0 offset1:136
    v_mov_b32 v38, 0
    v_mov_b32 v34, 0
    v_mfma_f32_16x16x16_bf16 v[18:21], v[36:37], v[36:37], 0
    s_cmp_lg_u32 s69, 0
    s_waitcnt lgkmcnt(2)
    v_smfmac_f32_16x16x64_bf16 v[42:45], v[90:93], a[160:167], v2
    s_waitcnt lgkmcnt(1)
    v_smfmac_f32_16x16x64_bf16 v[42:45], v[94:97], a[208:215], v2
    ds_read_b128 v[50:53], v15 offset:16384
    v_mov_b32 v40, 0
    v_smfmac_f32_16x16x64_bf16 v[46:49], v[90:93], a[168:175], v2
    ds_read_b128 v[54:57], v15 offset:17408
    ds_read_b128 v[62:65], v15 offset:19456
    v_smfmac_f32_16x16x64_bf16 v[46:49], v[94:97], a[216:223], v2
    ds_read_b128 v[58:61], v15 offset:18432
    v_add_f32 v42, v42, v43
    v_smfmac_f32_16x16x64_bf16 v[30:33], v[90:93], a[176:183], v2
    v_add_f32 v44, v44, v45
    v_smfmac_f32_16x16x64_bf16 v[30:33], v[94:97], a[224:231], v2
    ds_read_b128 v[66:69], v15 offset:20480
    v_cvt_pk_bf16_f32 v98, v42, v44
    v_and_or_b32 v98, v98, -2, s71
    v_add_f32 v46, v46, v47
    v_smfmac_f32_16x16x64_bf16 v[22:25], v[90:93], a[184:191], v2
    ds_read_b128 v[70:73], v15 offset:21504
    v_add_f32 v48, v48, v49
    v_cvt_pk_bf16_f32 v99, v46, v48
    v_smfmac_f32_16x16x64_bf16 v[22:25], v[94:97], a[232:239], v2
    ds_read_b128 v[74:77], v15 offset:22528
    v_add_f32 v30, v30, v31
    v_smfmac_f32_16x16x64_bf16 v[26:29], v[90:93], a[192:199], v2
    ds_read_b128 v[78:81], v15 offset:23552
    v_add_f32 v32, v32, v33
    v_cvt_pk_bf16_f32 v100, v30, v32
    v_smfmac_f32_16x16x64_bf16 v[26:29], v[94:97], a[240:247], v2
    v_add_f32 v22, v22, v23
    v_add_f32 v24, v24, v25
    v_cvt_pk_bf16_f32 v101, v22, v24
    v_smfmac_f32_16x16x64_bf16 v[38:41], v[90:93], a[200:207], v2
    buffer_store_dwordx4 v[98:101], v7, s[4:7], s60 offen sc1
    v_smfmac_f32_16x16x64_bf16 v[38:41], v[94:97], a[248:255], v2
    v_add_f32 v26, v26, v27
    s_waitcnt lgkmcnt(1)
    v_smfmac_f32_16x16x64_bf16 v[18:21], v[90:93], v[50:57], v2
    ds_read_b128 v[22:25], v0 offset:28928
    v_smfmac_f32_16x16x64_bf16 v[18:21], v[94:97], v[66:73], v2
    v_add_f32 v28, v28, v29
    v_cvt_pk_bf16_f32 v102, v26, v28
    v_and_or_b32 v102, v102, -2, s71
    v_add_f32 v38, v38, v39
    v_smfmac_f32_16x16x64_bf16 v[34:37], v[90:93], v[58:65], v2
    v_add_f32 v40, v40, v41
    v_cvt_pk_bf16_f32 v103, v38, v40
    s_waitcnt lgkmcnt(1)
    v_smfmac_f32_16x16x64_bf16 v[34:37], v[94:97], v[74:81], v2
    buffer_store_dwordx2 v[102:103], v17, s[4:7], s61 offen sc1
    v_add_f32 v20, v20, v21
    v_add_f32 v18, v18, v19
    v_cvt_pk_bf16_f32 v104, v18, v20
    v_and_or_b32 v104, v104, -2, s71
    s_nop 2
    v_add_f32 v34, v34, v35
    v_add_f32 v36, v36, v37
    v_cvt_pk_bf16_f32 v105, v34, v36
    buffer_store_dwordx2 v[104:105], v17, s[4:7], s15 offen sc1
L_hs_cend:
    ds_read_b128 v[50:53], v11 offset:8192
    ds_read_b128 v[54:57], v11 offset:12288
    ds_read_b128 v[58:61], v11 offset:16384
    ds_read_b128 v[62:65], v11 offset:20480
    ds_read_b128 v[66:69], v15 offset:8192
    ds_read_b128 v[70:73], v15 offset:9216
    ds_read_b128 v[74:77], v15 offset:10240
    ds_read_b128 v[78:81], v15 offset:11264
    s_cbranch_scc0 L_hs_rw0
    s_waitcnt vmcnt(3)
    v_mov_b64 v[106:107], v[128:129]
    v_mov_b64 v[108:109], v[130:131]
    s_xor_b32 s65, s65, 0x2000
    s_xor_b32 s66, s66, 0x2000
    s_add_u32 s67, s67, 1
    s_add_u32 s68, s68, 32768
    s_add_u32 s55, s67, 1
    s_min_u32 s55, s55, 63
    v_mov_b32 v123, -1
    s_waitcnt lgkmcnt(0)
    s_min_u32 s84, s84, s85
    s_min_u32 s84, s84, s86
    s_cmp_gt_u32 s84, s55
    s_cselect_b32 s83, 0, 1
    s_add_u32 s56, s55, 2
    s_min_u32 s56, s56, 63
    s_cmp_gt_u32 s84, s56
    s_cbranch_scc1 L_hs_nofla
    s_load_dwordx4 s[84:87], s[4:5], s3 glc
    s_branch L_hs_nospa
L_hs_nofla:
L_hs_nospa:
    s_nop 2
    s_cmp_lg_u32 s52, 3
    s_cbranch_scc1 L_hs_rw2
    s_nop 7
L_hs_rw2:
    buffer_load_dwordx4 v[38:41], v10, s[4:7], s62 offen sc1
    buffer_load_dwordx4 v[42:45], v10, s[4:7], s62 offen offset:1024 sc1
    s_nop 15
    s_nop 15
    s_nop 5
    buffer_load_dwordx4 v[26:29], v10, s[4:7], s62 offen sc1
    buffer_load_dwordx4 v[30:33], v10, s[4:7], s62 offen offset:1024 sc1
    s_branch L_hs_red0
L_hs_rw0:
    buffer_load_dwordx4 v[38:41], v10, s[4:7], s62 offen sc1
    buffer_load_dwordx4 v[42:45], v10, s[4:7], s62 offen offset:1024 sc1
    s_waitcnt vmcnt(5)
    v_mov_b64 v[106:107], v[128:129]
    v_mov_b64 v[108:109], v[130:131]
    s_xor_b32 s65, s65, 0x2000
    s_xor_b32 s66, s66, 0x2000
    s_add_u32 s67, s67, 1
    s_add_u32 s68, s68, 32768
    s_add_u32 s55, s67, 1
    s_min_u32 s55, s55, 63
    v_mov_b32 v123, -1
    s_waitcnt lgkmcnt(0)
    s_min_u32 s84, s84, s85
    s_min_u32 s84, s84, s86
    s_cmp_gt_u32 s84, s55
    s_cselect_b32 s83, 0, 1
    s_add_u32 s56, s55, 2
    s_min_u32 s56, s56, 63
    s_cmp_gt_u32 s84, s56
    s_cbranch_scc1 L_hs_noflb
    s_load_dwordx4 s[84:87], s[4:5], s3 glc
    s_branch L_hs_nospb
L_hs_noflb:
L_hs_nospb:
    s_nop 15
    s_nop 15
    buffer_load_dwordx4 v[26:29], v10, s[4:7], s62 offen sc1
    buffer_load_dwordx4 v[30:33], v10, s[4:7], s62 offen offset:1024 sc1
L_hs_red0:
    s_waitcnt vmcnt(3)
    v_mfma_f32_16x16x32_bf16 v[46:49], v[22:25], v[38:41], 0
    s_waitcnt vmcnt(2)
    v_mfma_f32_16x16x32_bf16 v[46:49], v[22:25], v[42:45], v[46:49]
    v_bitop3_b32 v122, v38, v42, s71 bitop3:0x7e
    v_bitop3_b32 v124, v40, v44, s71 bitop3:0x7e
    v_and_b32 v122, 1, v122
    v_and_or_b32 v122, v124, s14, v122
    v_cmp_ne_u32 vcc, 0, v122
    s_nop 2
    v_add_f32_dpp v46, v46, v46 row_ror:8 row_mask:0xf bank_mask:0xf
    v_add_f32_dpp v47, v47, v47 row_ror:8 row_mask:0xf bank_mask:0xf
    s_cbranch_vccnz L_hs_rretry0
    v_add_f32_dpp v46, v46, v46 row_ror:4 row_mask:0xf bank_mask:0xf
    v_add_f32_dpp v47, v47, v47 row_ror:4 row_mask:0xf bank_mask:0xf
    v_cvt_pk_bf16_f32 v48, v46, v47
    buffer_store_dword v48, v8, s[4:7], s63 offen sc1
L_hs_rok:
    s_xor_b32 s63, s63, 0x2000
    buffer_store_dword v123, v8, s[4:7], s63 offen sc1
    s_xor_b32 s71, s71, 1
    s_nop 15
    s_nop 6
    s_cmp_lg_u32 s83, 0
    s_cbranch_scc1 L_hs_kvchk
L_hs_kvok:
    s_barrier
    buffer_load_dwordx4 v[18:21], v10, s[4:7], s65 offen sc1
    s_nop 1
    buffer_load_dwordx4 v[34:37], v10, s[4:7], s66 offen sc1
    v_bfe_u32 v124, v0, 8, 2
    v_mul_u32_u24 v124, 288, v124
    v_add3_u32 v124, v124, v0, s13
    ds_read_b128 v[124:127], v124
    v_mov_b64 v[110:111], v[132:133]
    v_mov_b64 v[112:113], v[134:135]
    v_mov_b64 v[114:115], v[136:137]
    v_mov_b64 v[116:117], v[138:139]
    v_mov_b64 v[118:119], v[140:141]
    v_mov_b64 v[120:121], v[142:143]
    v_mov_b64 v[82:83], 0
    v_mov_b64 v[84:85], 0
    v_mov_b64 v[86:87], 0
    v_mov_b64 v[88:89], 0
    v_mov_b64 v[90:91], 0
    v_mov_b64 v[92:93], 0
    v_mov_b64 v[94:95], 0
    v_mov_b64 v[96:97], 0
    v_mov_b64 v[98:99], 0
    s_nop 0
    buffer_load_dwordx4 v[18:21], v10, s[4:7], s65 offen sc1
    buffer_load_dwordx4 v[34:37], v10, s[4:7], s66 offen sc1
    v_mov_b64 v[100:101], 0
    v_mov_b64 v[102:103], 0
    v_mov_b64 v[104:105], 0
    s_branch L_hs_loop
L_hs_p1retry:
    s_mov_b64 exec, vcc
    buffer_load_dwordx4 v[18:21], v10, s[4:7], s65 offen sc1
    buffer_load_dwordx4 v[34:37], v10, s[4:7], s66 offen sc1
    s_mov_b64 exec, -1
    v_mov_b64 v[82:83], 0
    v_mov_b64 v[84:85], 0
    s_nop 0
    v_mov_b64 v[86:87], 0
    v_mov_b64 v[88:89], 0
    v_mov_b64 v[98:99], 0
    v_mov_b64 v[100:101], 0
    v_mov_b64 v[102:103], 0
    v_mov_b64 v[104:105], 0
    s_add_u32 s79, s79, 1
    s_sub_u32 s59, s59, 1
    s_cbranch_scc1 L_timeout
    s_branch L_hs_loop
L_hs_kvchk:
    s_waitcnt lgkmcnt(0)
    s_min_u32 s84, s84, s85
    s_min_u32 s84, s84, s86
    s_cmp_gt_u32 s84, s55
    s_cbranch_scc1 L_hs_kvok
L_kvw_3:
    s_load_dwordx4 s[84:87], s[4:5], s3 glc
    s_waitcnt lgkmcnt(0)
    s_min_u32 s84, s84, s85
    s_min_u32 s84, s84, s86
    s_cmp_gt_u32 s84, s55
    s_cbranch_scc1 L_hs_kvok
    s_sub_u32 s59, s59, 1
    s_cbranch_scc1 L_timeout
    s_sleep 1
    s_branch L_kvw_3
L_hs_rretry0:
    buffer_load_dwordx4 v[38:41], v10, s[4:7], s62 offen sc1
    buffer_load_dwordx4 v[42:45], v10, s[4:7], s62 offen offset:1024 sc1
    s_add_u32 s101, s101, 1
    s_sub_u32 s59, s59, 1
    s_cbranch_scc1 L_timeout
L_hs_red1:
    s_waitcnt vmcnt(3)
    v_mfma_f32_16x16x32_bf16 v[46:49], v[22:25], v[26:29], 0
    s_waitcnt vmcnt(2)
    v_mfma_f32_16x16x32_bf16 v[46:49], v[22:25], v[30:33], v[46:49]
    v_bitop3_b32 v122, v26, v30, s71 bitop3:0x7e
    v_bitop3_b32 v124, v28, v32, s71 bitop3:0x7e
    v_and_b32 v122, 1, v122
    v_and_or_b32 v122, v124, s14, v122
    v_cmp_ne_u32 vcc, 0, v122
    s_nop 2
    v_add_f32_dpp v46, v46, v46 row_ror:8 row_mask:0xf bank_mask:0xf
    v_add_f32_dpp v47, v47, v47 row_ror:8 row_mask:0xf bank_mask:0xf
    s_cbranch_vccnz L_hs_rretry1
    v_add_f32_dpp v46, v46, v46 row_ror:4 row_mask:0xf bank_mask:0xf
    v_add_f32_dpp v47, v47, v47 row_ror:4 row_mask:0xf bank_mask:0xf
    v_cvt_pk_bf16_f32 v48, v46, v47
    buffer_store_dword v48, v8, s[4:7], s63 offen sc1
    s_branch L_hs_rok
L_hs_rretry1:
    buffer_load_dwordx4 v[26:29], v10, s[4:7], s62 offen sc1
    buffer_load_dwordx4 v[30:33], v10, s[4:7], s62 offen offset:1024 sc1
    s_add_u32 s101, s101, 1
    s_sub_u32 s59, s59, 1
    s_cbranch_scc1 L_timeout
    s_branch L_hs_red0
L_hs_slow:
    v_mov_b32_dpp v98, v124 quad_perm:[0,0,2,2] row_mask:0xf bank_mask:0xf
    v_mov_b32_dpp v99, v126 quad_perm:[0,0,2,2] row_mask:0xf bank_mask:0xf
    s_nop 0
    v_add_f32_dpp v98, v125, v98 quad_perm:[1,1,3,3] row_mask:0xf bank_mask:0xf
    v_add_f32_dpp v99, v127, v99 quad_perm:[1,1,3,3] row_mask:0xf bank_mask:0xf
    v_max3_f32 v122, v98, v99, v82
    v_max_f32 v122, v122, v83
    v_mov_b32 v123, v122
    s_nop 1
    v_permlane16_swap_b32 v122, v123
    v_max_f32 v122, v122, v123
    v_mov_b32 v123, v122
    s_nop 1
    v_permlane32_swap_b32 v122, v123
    v_max_f32 v122, v122, v123
    ds_write_b32 v1, v122 offset:1024
    s_waitcnt lgkmcnt(0)
    s_barrier
    ds_read2st64_b32 v[106:107], v3 offset0:4 offset1:5
    ds_read2st64_b32 v[108:109], v3 offset0:6 offset1:7
    s_waitcnt lgkmcnt(0)
    v_max3_f32 v122, v106, v107, v108
    v_max_f32 v122, v122, v109
    v_sub_f32 v98, v98, v122
    v_sub_f32 v99, v99, v122
    v_sub_f32 v82, v82, v122
    v_sub_f32 v83, v83, v122
    v_exp_f32 v98, v98
    v_exp_f32 v99, v99
    v_exp_f32 v82, v82
    v_exp_f32 v83, v83
    v_cvt_pk_bf16_f32 v122, v98, v99
    ds_write_b32 v1, v122 offset:0
    v_cvt_pk_bf16_f32 v34, v82, v83
    s_waitcnt lgkmcnt(0)
    s_barrier
    ds_read2st64_b32 v[106:107], v3 offset0:0 offset1:1
    ds_read2st64_b32 v[108:109], v3 offset0:2 offset1:3
    s_waitcnt lgkmcnt(0)
    v_mfma_f32_16x16x32_bf16 v[110:113], v[18:21], v[106:109], 0
    v_mfma_f32_16x16x32_bf16 v[22:25], v[114:117], v[106:109], 0
    v_mfma_f32_16x16x32_bf16 v[26:29], v[118:121], v[106:109], 0
    v_mfma_f32_16x16x16_bf16 v[110:113], v[18:19], v[34:35], v[110:113]
    v_mfma_f32_16x16x16_bf16 v[22:25], v[38:39], v[34:35], v[22:25]
    v_mfma_f32_16x16x16_bf16 v[26:29], v[40:41], v[34:35], v[26:29]
    v_rcp_f32 v110, v110
    s_nop 0
    v_cndmask_b32 v112, v110, 0, s[72:73]
    v_cndmask_b32 v113, 0, v110, s[72:73]
    v_mul_f32 v98, v22, v112
    v_mul_f32 v99, v23, v112
    v_mul_f32 v100, v24, v112
    v_mul_f32 v101, v25, v112
    v_pk_fma_f32 v[98:99], v[26:27], v[112:113], v[98:99] op_sel:[0,1,0] op_sel_hi:[1,1,1]
    v_pk_fma_f32 v[100:101], v[28:29], v[112:113], v[100:101] op_sel:[0,1,0] op_sel_hi:[1,1,1]
    v_cvt_pk_bf16_f32 v102, v98, v99
    v_cvt_pk_bf16_f32 v103, v100, v101
    ds_write_b64 v9, v[102:103]
    s_branch L_hs_soft_ok
L_hs_done:
    ds_write2_b32 v4, v38, v40 offset0:0 offset1:136
    s_waitcnt lgkmcnt(0)
    s_barrier
    v_bfe_u32 v124, v0, 8, 2
    v_mul_u32_u24 v124, 288, v124
    v_add3_u32 v124, v124, v0, s13
    ds_read_b128 v[124:127], v124
    s_waitcnt lgkmcnt(0)
    buffer_store_dwordx4 v[124:127], v10, s[4:7], s76 offen sc1
    s_waitcnt vmcnt(0)
    s_branch L_end
L_qkv:
    v_mov_b32 v8, v0
    v_lshrrev_b32 v9, 4, v8
    v_and_b32 v10, 15, v8
    s_sub_u32 s55, s53, 32
    s_mul_hi_u32 s60, s55, 0x55555556
    s_mul_i32 s56, s60, 3
    s_sub_u32 s61, s55, s56
    v_lshlrev_b32 v11, 1, v9
    v_xor_b32 v11, v11, v10
    v_lshlrev_b32 v16, 4, v11
    v_xor_b32 v17, 128, v16
    v_lshrrev_b32 v11, 2, v10
    v_and_b32 v12, 1, v9
    v_lshl_add_u32 v12, v12, 2, v11
    v_lshlrev_b32 v12, 5, v12
    v_lshl_add_u32 v11, v9, 3, v11
    v_lshlrev_b32 v11, 8, v11
    v_and_b32 v18, 3, v10
    v_lshlrev_b32 v18, 3, v18
    s_lshl_b32 s55, s52, 6
    v_add_u32 v18, s55, v18
    v_xor_b32 v18, v18, v12
    v_add_u32 v18, v18, v11
    v_xor_b32 v19, 32, v18
    s_lshl_b32 s58, s52, 15
    v_lshl_add_u32 v16, v9, 13, v16
    v_lshl_add_u32 v17, v9, 13, v17
    s_lshl_b32 s55, s52, 19
    s_lshl_b32 s56, s60, 8
    s_add_u32 s73, s55, s56
    s_add_u32 m0, s58, 0
    s_add_u32 s55, s73, 0
    buffer_load_dwordx4 v16, s[24:27], s55 offen  lds
    s_add_u32 m0, s58, 1024
    s_add_u32 s55, s73, 32768
    buffer_load_dwordx4 v16, s[24:27], s55 offen  lds
    s_add_u32 m0, s58, 2048
    s_add_u32 s55, s73, 65536
    buffer_load_dwordx4 v17, s[24:27], s55 offen  lds
    s_add_u32 m0, s58, 3072
    s_add_u32 s55, s73, 98304
    buffer_load_dwordx4 v17, s[24:27], s55 offen  lds
    s_add_u32 m0, s58, 4096
    s_add_u32 s55, s73, 131072
    buffer_load_dwordx4 v16, s[24:27], s55 offen  lds
    s_add_u32 m0, s58, 5120
    s_add_u32 s55, s73, 163840
    buffer_load_dwordx4 v16, s[24:27], s55 offen  lds
    s_add_u32 m0, s58, 6144
    s_add_u32 s55, s73, 196608
    buffer_load_dwordx4 v17, s[24:27], s55 offen  lds
    s_add_u32 m0, s58, 7168
    s_add_u32 s55, s73, 229376
    buffer_load_dwordx4 v17, s[24:27], s55 offen  lds
    s_add_u32 m0, s58, 8192
    s_add_u32 s55, s73, 262144
    buffer_load_dwordx4 v16, s[24:27], s55 offen  lds
    s_add_u32 m0, s58, 9216
    s_add_u32 s55, s73, 294912
    buffer_load_dwordx4 v16, s[24:27], s55 offen  lds
    s_add_u32 m0, s58, 10240
    s_add_u32 s55, s73, 327680
    buffer_load_dwordx4 v17, s[24:27], s55 offen  lds
    s_add_u32 m0, s58, 11264
    s_add_u32 s55, s73, 360448
    buffer_load_dwordx4 v17, s[24:27], s55 offen  lds
    s_add_u32 m0, s58, 12288
    s_add_u32 s55, s73, 393216
    buffer_load_dwordx4 v16, s[24:27], s55 offen  lds
    s_add_u32 m0, s58, 13312
    s_add_u32 s55, s73, 425984
    buffer_load_dwordx4 v16, s[24:27], s55 offen  lds
    s_add_u32 m0, s58, 14336
    s_add_u32 s55, s73, 458752
    buffer_load_dwordx4 v17, s[24:27], s55 offen  lds
    s_add_u32 m0, s58, 15360
    s_add_u32 s55, s73, 491520
    buffer_load_dwordx4 v17, s[24:27], s55 offen  lds
    s_add_u32 m0, s58, 16384
    s_add_u32 s55, s73, 2097152
    buffer_load_dwordx4 v16, s[24:27], s55 offen  lds
    s_add_u32 m0, s58, 17408
    s_add_u32 s55, s73, 2129920
    buffer_load_dwordx4 v16, s[24:27], s55 offen  lds
    s_add_u32 m0, s58, 18432
    s_add_u32 s55, s73, 2162688
    buffer_load_dwordx4 v17, s[24:27], s55 offen  lds
    s_add_u32 m0, s58, 19456
    s_add_u32 s55, s73, 2195456
    buffer_load_dwordx4 v17, s[24:27], s55 offen  lds
    s_add_u32 m0, s58, 20480
    s_add_u32 s55, s73, 2228224
    buffer_load_dwordx4 v16, s[24:27], s55 offen  lds
    s_add_u32 m0, s58, 21504
    s_add_u32 s55, s73, 2260992
    buffer_load_dwordx4 v16, s[24:27], s55 offen  lds
    s_add_u32 m0, s58, 22528
    s_add_u32 s55, s73, 2293760
    buffer_load_dwordx4 v17, s[24:27], s55 offen  lds
    s_add_u32 m0, s58, 23552
    s_add_u32 s55, s73, 2326528
    buffer_load_dwordx4 v17, s[24:27], s55 offen  lds
    s_add_u32 m0, s58, 24576
    s_add_u32 s55, s73, 2359296
    buffer_load_dwordx4 v16, s[24:27], s55 offen  lds
    s_add_u32 m0, s58, 25600
    s_add_u32 s55, s73, 2392064
    buffer_load_dwordx4 v16, s[24:27], s55 offen  lds
    s_add_u32 m0, s58, 26624
    s_add_u32 s55, s73, 2424832
    buffer_load_dwordx4 v17, s[24:27], s55 offen  lds
    s_add_u32 m0, s58, 27648
    s_add_u32 s55, s73, 2457600
    buffer_load_dwordx4 v17, s[24:27], s55 offen  lds
    s_add_u32 m0, s58, 28672
    s_add_u32 s55, s73, 2490368
    buffer_load_dwordx4 v16, s[24:27], s55 offen  lds
    s_add_u32 m0, s58, 29696
    s_add_u32 s55, s73, 2523136
    buffer_load_dwordx4 v16, s[24:27], s55 offen  lds
    s_add_u32 m0, s58, 30720
    s_add_u32 s55, s73, 2555904
    buffer_load_dwordx4 v17, s[24:27], s55 offen  lds
    s_add_u32 m0, s58, 31744
    s_add_u32 s55, s73, 2588672
    buffer_load_dwordx4 v17, s[24:27], s55 offen  lds
    v_add_u32 v20, 32768, v18
    v_add_u32 v21, 32768, v19
    v_add_u32 v22, 65536, v18
    v_add_u32 v23, 65536, v19
    v_add_u32 v24, 98304, v18
    v_add_u32 v25, 98304, v19
    v_lshlrev_b32 v1, 4, v8
    v_lshrrev_b32 v11, 2, v10
    v_lshlrev_b32 v11, 1, v11
    v_lshl_add_u32 v11, v9, 3, v11
    v_and_b32 v12, 1, v10
    v_add_u32 v11, v11, v12
    v_lshlrev_b32 v11, 4, v11
    v_and_b32 v12, 2, v10
    v_lshl_add_u32 v2, v12, 11, v11
    v_lshrrev_b32 v11, 1, v10
    v_lshlrev_b32 v11, 8, v11
    v_lshl_add_u32 v7, v9, 4, v11
    v_lshlrev_b32 v11, 9, v9
    v_lshl_add_u32 v6, v10, 2, v11
    s_mul_i32 s55, s60, 2097152
    s_add_u32 s66, s55, 0x2000000
    s_mov_b32 s67, 0x3e0293ee
    s_mov_b32 s62, s61
    s_mov_b32 s63, s61
    s_mov_b32 s68, 0
    s_mov_b32 s3, 0
    s_mov_b32 s69, 0
    s_lshl_b32 s55, s60, 7
    s_lshl_b32 s56, s61, 2
    s_add_u32 s70, s55, s56
    s_add_u32 s70, s70, 4096
    s_add_u32 s72, s55, 0
    s_lshl_b32 s55, s61, 12
    s_lshl_b32 s56, s60, 7
    s_add_u32 s71, s55, s56
    s_add_u32 s71, s71, 8192
    s_and_b32 s56, s52, 1
    s_lshl_b32 s56, s56, 2
    s_add_u32 s71, s71, s56
    s_lshr_b32 s56, s52, 1
    s_lshl_b32 s56, s56, 3
    s_add_u32 s71, s71, s56
    s_mov_b32 s77, 0
    s_lshr_b32 s75, s52, 1
    v_lshlrev_b32 v11, 2, v9
    v_add_u32 v12, 0, v11
    v_cmp_le_u32 vcc, v12, v10
    s_cmp_eq_u32 s75, 0
    s_cselect_b64 s[78:79], vcc, -1
    s_cselect_b64 s[86:87], 0, vcc
    v_add_u32 v12, 1, v11
    v_cmp_le_u32 vcc, v12, v10
    s_cmp_eq_u32 s75, 0
    s_cselect_b64 s[80:81], vcc, -1
    s_cselect_b64 s[88:89], 0, vcc
    v_add_u32 v12, 2, v11
    v_cmp_le_u32 vcc, v12, v10
    s_cmp_eq_u32 s75, 0
    s_cselect_b64 s[82:83], vcc, -1
    s_cselect_b64 s[90:91], 0, vcc
    v_add_u32 v12, 3, v11
    v_cmp_le_u32 vcc, v12, v10
    s_cmp_eq_u32 s75, 0
    s_cselect_b64 s[84:85], vcc, -1
    s_cselect_b64 s[92:93], 0, vcc
    s_lshl_b32 s56, s52, 13
    s_lshl_b32 s64, s61, 15
    s_add_u32 s64, s64, s56
    s_add_u32 s64, s64, 0x200000
    s_add_u32 s65, s56, 0x20000
    v_add_u32 v3, 0x20000, v1
    v_mov_b32 v30, 0
    v_lshlrev_b32 v31, 3, v8
    s_mov_b32 s74, 0
    s_waitcnt vmcnt(24)
    s_barrier
    ds_read_b64_tr_b16 v[128:129], v18 offset:0
    ds_read_b64_tr_b16 v[130:131], v18 offset:1024
    ds_read_b64_tr_b16 v[136:137], v19 offset:0
    ds_read_b64_tr_b16 v[138:139], v19 offset:1024
    ds_read_b64_tr_b16 v[144:145], v20 offset:0
    ds_read_b64_tr_b16 v[146:147], v20 offset:1024
    ds_read_b64_tr_b16 v[152:153], v21 offset:0
    ds_read_b64_tr_b16 v[154:155], v21 offset:1024
    ds_read_b64_tr_b16 v[160:161], v22 offset:0
    ds_read_b64_tr_b16 v[162:163], v22 offset:1024
    ds_read_b64_tr_b16 v[168:169], v23 offset:0
    ds_read_b64_tr_b16 v[170:171], v23 offset:1024
    s_waitcnt lgkmcnt(8)
    ds_read_b64_tr_b16 v[176:177], v24 offset:0
    ds_read_b64_tr_b16 v[178:179], v24 offset:1024
    ds_read_b64_tr_b16 v[184:185], v25 offset:0
    ds_read_b64_tr_b16 v[186:187], v25 offset:1024
    s_waitcnt lgkmcnt(0)
    s_barrier
    s_add_u32 m0, s58, 0
    s_add_u32 s55, s73, 0
    buffer_load_dwordx4 v16, s[28:31], s55 offen  lds
    s_add_u32 m0, s58, 1024
    s_add_u32 s55, s73, 32768
    buffer_load_dwordx4 v16, s[28:31], s55 offen  lds
    s_add_u32 m0, s58, 2048
    s_add_u32 s55, s73, 65536
    buffer_load_dwordx4 v17, s[28:31], s55 offen  lds
    s_add_u32 m0, s58, 3072
    s_add_u32 s55, s73, 98304
    buffer_load_dwordx4 v17, s[28:31], s55 offen  lds
    s_add_u32 m0, s58, 4096
    s_add_u32 s55, s73, 131072
    buffer_load_dwordx4 v16, s[28:31], s55 offen  lds
    s_add_u32 m0, s58, 5120
    s_add_u32 s55, s73, 163840
    buffer_load_dwordx4 v16, s[28:31], s55 offen  lds
    s_add_u32 m0, s58, 6144
    s_add_u32 s55, s73, 196608
    buffer_load_dwordx4 v17, s[28:31], s55 offen  lds
    s_add_u32 m0, s58, 7168
    s_add_u32 s55, s73, 229376
    buffer_load_dwordx4 v17, s[28:31], s55 offen  lds
    s_waitcnt vmcnt(24)
    s_barrier
    ds_read_b64_tr_b16 v[132:133], v18 offset:8192
    ds_read_b64_tr_b16 v[134:135], v18 offset:9216
    ds_read_b64_tr_b16 v[140:141], v19 offset:8192
    ds_read_b64_tr_b16 v[142:143], v19 offset:9216
    ds_read_b64_tr_b16 v[148:149], v20 offset:8192
    ds_read_b64_tr_b16 v[150:151], v20 offset:9216
    ds_read_b64_tr_b16 v[156:157], v21 offset:8192
    ds_read_b64_tr_b16 v[158:159], v21 offset:9216
    ds_read_b64_tr_b16 v[164:165], v22 offset:8192
    ds_read_b64_tr_b16 v[166:167], v22 offset:9216
    ds_read_b64_tr_b16 v[172:173], v23 offset:8192
    ds_read_b64_tr_b16 v[174:175], v23 offset:9216
    s_waitcnt lgkmcnt(8)
    ds_read_b64_tr_b16 v[180:181], v24 offset:8192
    ds_read_b64_tr_b16 v[182:183], v24 offset:9216
    ds_read_b64_tr_b16 v[188:189], v25 offset:8192
    ds_read_b64_tr_b16 v[190:191], v25 offset:9216
    s_waitcnt lgkmcnt(0)
    s_barrier
    s_add_u32 m0, s58, 8192
    s_add_u32 s55, s73, 262144
    buffer_load_dwordx4 v16, s[28:31], s55 offen  lds
    s_add_u32 m0, s58, 9216
    s_add_u32 s55, s73, 294912
    buffer_load_dwordx4 v16, s[28:31], s55 offen  lds
    s_add_u32 m0, s58, 10240
    s_add_u32 s55, s73, 327680
    buffer_load_dwordx4 v17, s[28:31], s55 offen  lds
    s_add_u32 m0, s58, 11264
    s_add_u32 s55, s73, 360448
    buffer_load_dwordx4 v17, s[28:31], s55 offen  lds
    s_add_u32 m0, s58, 12288
    s_add_u32 s55, s73, 393216
    buffer_load_dwordx4 v16, s[28:31], s55 offen  lds
    s_add_u32 m0, s58, 13312
    s_add_u32 s55, s73, 425984
    buffer_load_dwordx4 v16, s[28:31], s55 offen  lds
    s_add_u32 m0, s58, 14336
    s_add_u32 s55, s73, 458752
    buffer_load_dwordx4 v17, s[28:31], s55 offen  lds
    s_add_u32 m0, s58, 15360
    s_add_u32 s55, s73, 491520
    buffer_load_dwordx4 v17, s[28:31], s55 offen  lds
    s_waitcnt vmcnt(24)
    s_barrier
    ds_read_b64_tr_b16 v[192:193], v18 offset:16384
    ds_read_b64_tr_b16 v[194:195], v18 offset:17408
    ds_read_b64_tr_b16 v[200:201], v19 offset:16384
    ds_read_b64_tr_b16 v[202:203], v19 offset:17408
    ds_read_b64_tr_b16 v[208:209], v20 offset:16384
    ds_read_b64_tr_b16 v[210:211], v20 offset:17408
    ds_read_b64_tr_b16 v[216:217], v21 offset:16384
    ds_read_b64_tr_b16 v[218:219], v21 offset:17408
    ds_read_b64_tr_b16 v[224:225], v22 offset:16384
    ds_read_b64_tr_b16 v[226:227], v22 offset:17408
    ds_read_b64_tr_b16 v[232:233], v23 offset:16384
    ds_read_b64_tr_b16 v[234:235], v23 offset:17408
    s_waitcnt lgkmcnt(8)
    ds_read_b64_tr_b16 v[240:241], v24 offset:16384
    ds_read_b64_tr_b16 v[242:243], v24 offset:17408
    ds_read_b64_tr_b16 v[248:249], v25 offset:16384
    ds_read_b64_tr_b16 v[250:251], v25 offset:17408
    s_waitcnt lgkmcnt(0)
    s_barrier
    s_add_u32 m0, s58, 16384
    s_add_u32 s55, s73, 2097152
    buffer_load_dwordx4 v16, s[28:31], s55 offen  lds
    s_add_u32 m0, s58, 17408
    s_add_u32 s55, s73, 2129920
    buffer_load_dwordx4 v16, s[28:31], s55 offen  lds
    s_add_u32 m0, s58, 18432
    s_add_u32 s55, s73, 2162688
    buffer_load_dwordx4 v17, s[28:31], s55 offen  lds
    s_add_u32 m0, s58, 19456
    s_add_u32 s55, s73, 2195456
    buffer_load_dwordx4 v17, s[28:31], s55 offen  lds
    s_add_u32 m0, s58, 20480
    s_add_u32 s55, s73, 2228224
    buffer_load_dwordx4 v16, s[28:31], s55 offen  lds
    s_add_u32 m0, s58, 21504
    s_add_u32 s55, s73, 2260992
    buffer_load_dwordx4 v16, s[28:31], s55 offen  lds
    s_add_u32 m0, s58, 22528
    s_add_u32 s55, s73, 2293760
    buffer_load_dwordx4 v17, s[28:31], s55 offen  lds
    s_add_u32 m0, s58, 23552
    s_add_u32 s55, s73, 2326528
    buffer_load_dwordx4 v17, s[28:31], s55 offen  lds
    s_waitcnt vmcnt(24)
    s_barrier
    ds_read_b64_tr_b16 v[196:197], v18 offset:24576
    ds_read_b64_tr_b16 v[198:199], v18 offset:25600
    ds_read_b64_tr_b16 v[204:205], v19 offset:24576
    ds_read_b64_tr_b16 v[206:207], v19 offset:25600
    ds_read_b64_tr_b16 v[212:213], v20 offset:24576
    ds_read_b64_tr_b16 v[214:215], v20 offset:25600
    ds_read_b64_tr_b16 v[220:221], v21 offset:24576
    ds_read_b64_tr_b16 v[222:223], v21 offset:25600
    ds_read_b64_tr_b16 v[228:229], v22 offset:24576
    ds_read_b64_tr_b16 v[230:231], v22 offset:25600
    ds_read_b64_tr_b16 v[236:237], v23 offset:24576
    ds_read_b64_tr_b16 v[238:239], v23 offset:25600
    s_waitcnt lgkmcnt(8)
    ds_read_b64_tr_b16 v[244:245], v24 offset:24576
    ds_read_b64_tr_b16 v[246:247], v24 offset:25600
    ds_read_b64_tr_b16 v[252:253], v25 offset:24576
    ds_read_b64_tr_b16 v[254:255], v25 offset:25600
    s_waitcnt lgkmcnt(0)
    s_barrier
    s_add_u32 m0, s58, 24576
    s_add_u32 s55, s73, 2359296
    buffer_load_dwordx4 v16, s[28:31], s55 offen  lds
    s_add_u32 m0, s58, 25600
    s_add_u32 s55, s73, 2392064
    buffer_load_dwordx4 v16, s[28:31], s55 offen  lds
    s_add_u32 m0, s58, 26624
    s_add_u32 s55, s73, 2424832
    buffer_load_dwordx4 v17, s[28:31], s55 offen  lds
    s_add_u32 m0, s58, 27648
    s_add_u32 s55, s73, 2457600
    buffer_load_dwordx4 v17, s[28:31], s55 offen  lds
    s_add_u32 m0, s58, 28672
    s_add_u32 s55, s73, 2490368
    buffer_load_dwordx4 v16, s[28:31], s55 offen  lds
    s_add_u32 m0, s58, 29696
    s_add_u32 s55, s73, 2523136
    buffer_load_dwordx4 v16, s[28:31], s55 offen  lds
    s_add_u32 m0, s58, 30720
    s_add_u32 s55, s73, 2555904
    buffer_load_dwordx4 v17, s[28:31], s55 offen  lds
    s_add_u32 m0, s58, 31744
    s_add_u32 s55, s73, 2588672
    buffer_load_dwordx4 v17, s[28:31], s55 offen  lds
    s_waitcnt vmcnt(24)
    s_barrier
    ds_read_b64_tr_b16 a[0:1], v18 offset:0
    ds_read_b64_tr_b16 a[2:3], v18 offset:1024
    ds_read_b64_tr_b16 a[8:9], v19 offset:0
    ds_read_b64_tr_b16 a[10:11], v19 offset:1024
    ds_read_b64_tr_b16 a[16:17], v20 offset:0
    ds_read_b64_tr_b16 a[18:19], v20 offset:1024
    ds_read_b64_tr_b16 a[24:25], v21 offset:0
    ds_read_b64_tr_b16 a[26:27], v21 offset:1024
    ds_read_b64_tr_b16 a[32:33], v22 offset:0
    ds_read_b64_tr_b16 a[34:35], v22 offset:1024
    ds_read_b64_tr_b16 a[40:41], v23 offset:0
    ds_read_b64_tr_b16 a[42:43], v23 offset:1024
    s_waitcnt lgkmcnt(8)
    ds_read_b64_tr_b16 a[48:49], v24 offset:0
    ds_read_b64_tr_b16 a[50:51], v24 offset:1024
    ds_read_b64_tr_b16 a[56:57], v25 offset:0
    ds_read_b64_tr_b16 a[58:59], v25 offset:1024
    s_waitcnt lgkmcnt(0)
    s_barrier
    buffer_load_dword v28, v30, s[8:11], 0 offen offset:16 sc1
    s_add_u32 m0, s58, 0
    s_add_u32 s55, s73, 0
    buffer_load_dwordx4 v16, s[20:23], s55 offen  lds
    s_add_u32 m0, s58, 1024
    s_add_u32 s55, s73, 32768
    buffer_load_dwordx4 v16, s[20:23], s55 offen  lds
    s_add_u32 m0, s58, 2048
    s_add_u32 s55, s73, 65536
    buffer_load_dwordx4 v17, s[20:23], s55 offen  lds
    s_add_u32 m0, s58, 3072
    s_add_u32 s55, s73, 98304
    buffer_load_dwordx4 v17, s[20:23], s55 offen  lds
    s_add_u32 m0, s58, 4096
    s_add_u32 s55, s73, 131072
    buffer_load_dwordx4 v16, s[20:23], s55 offen  lds
    s_add_u32 m0, s58, 5120
    s_add_u32 s55, s73, 163840
    buffer_load_dwordx4 v16, s[20:23], s55 offen  lds
    s_add_u32 m0, s58, 6144
    s_add_u32 s55, s73, 196608
    buffer_load_dwordx4 v17, s[20:23], s55 offen  lds
    s_add_u32 m0, s58, 7168
    s_add_u32 s55, s73, 229376
    buffer_load_dwordx4 v17, s[20:23], s55 offen  lds
    s_waitcnt vmcnt(24)
    s_barrier
    ds_read_b64_tr_b16 a[4:5], v18 offset:8192
    ds_read_b64_tr_b16 a[6:7], v18 offset:9216
    ds_read_b64_tr_b16 a[12:13], v19 offset:8192
    ds_read_b64_tr_b16 a[14:15], v19 offset:9216
    ds_read_b64_tr_b16 a[20:21], v20 offset:8192
    ds_read_b64_tr_b16 a[22:23], v20 offset:9216
    ds_read_b64_tr_b16 a[28:29], v21 offset:8192
    ds_read_b64_tr_b16 a[30:31], v21 offset:9216
    ds_read_b64_tr_b16 a[36:37], v22 offset:8192
    ds_read_b64_tr_b16 a[38:39], v22 offset:9216
    ds_read_b64_tr_b16 a[44:45], v23 offset:8192
    ds_read_b64_tr_b16 a[46:47], v23 offset:9216
    s_waitcnt lgkmcnt(8)
    ds_read_b64_tr_b16 a[52:53], v24 offset:8192
    ds_read_b64_tr_b16 a[54:55], v24 offset:9216
    ds_read_b64_tr_b16 a[60:61], v25 offset:8192
    ds_read_b64_tr_b16 a[62:63], v25 offset:9216
    s_waitcnt lgkmcnt(0)
    s_barrier
    s_add_u32 m0, s58, 8192
    s_add_u32 s55, s73, 262144
    buffer_load_dwordx4 v16, s[20:23], s55 offen  lds
    s_add_u32 m0, s58, 9216
    s_add_u32 s55, s73, 294912
    buffer_load_dwordx4 v16, s[20:23], s55 offen  lds
    s_add_u32 m0, s58, 10240
    s_add_u32 s55, s73, 327680
    buffer_load_dwordx4 v17, s[20:23], s55 offen  lds
    s_add_u32 m0, s58, 11264
    s_add_u32 s55, s73, 360448
    buffer_load_dwordx4 v17, s[20:23], s55 offen  lds
    s_add_u32 m0, s58, 12288
    s_add_u32 s55, s73, 393216
    buffer_load_dwordx4 v16, s[20:23], s55 offen  lds
    s_add_u32 m0, s58, 13312
    s_add_u32 s55, s73, 425984
    buffer_load_dwordx4 v16, s[20:23], s55 offen  lds
    s_add_u32 m0, s58, 14336
    s_add_u32 s55, s73, 458752
    buffer_load_dwordx4 v17, s[20:23], s55 offen  lds
    s_add_u32 m0, s58, 15360
    s_add_u32 s55, s73, 491520
    buffer_load_dwordx4 v17, s[20:23], s55 offen  lds
    s_waitcnt vmcnt(24)
    s_barrier
    ds_read_b64_tr_b16 a[64:65], v18 offset:16384
    ds_read_b64_tr_b16 a[66:67], v18 offset:17408
    ds_read_b64_tr_b16 a[72:73], v19 offset:16384
    ds_read_b64_tr_b16 a[74:75], v19 offset:17408
    ds_read_b64_tr_b16 a[80:81], v20 offset:16384
    ds_read_b64_tr_b16 a[82:83], v20 offset:17408
    ds_read_b64_tr_b16 a[88:89], v21 offset:16384
    ds_read_b64_tr_b16 a[90:91], v21 offset:17408
    ds_read_b64_tr_b16 a[96:97], v22 offset:16384
    ds_read_b64_tr_b16 a[98:99], v22 offset:17408
    ds_read_b64_tr_b16 a[104:105], v23 offset:16384
    ds_read_b64_tr_b16 a[106:107], v23 offset:17408
    s_waitcnt lgkmcnt(8)
    ds_read_b64_tr_b16 a[112:113], v24 offset:16384
    ds_read_b64_tr_b16 a[114:115], v24 offset:17408
    ds_read_b64_tr_b16 a[120:121], v25 offset:16384
    ds_read_b64_tr_b16 a[122:123], v25 offset:17408
    s_waitcnt lgkmcnt(0)
    s_barrier
    s_add_u32 m0, s58, 16384
    s_add_u32 s55, s73, 2097152
    buffer_load_dwordx4 v16, s[20:23], s55 offen  lds
    s_add_u32 m0, s58, 17408
    s_add_u32 s55, s73, 2129920
    buffer_load_dwordx4 v16, s[20:23], s55 offen  lds
    s_add_u32 m0, s58, 18432
    s_add_u32 s55, s73, 2162688
    buffer_load_dwordx4 v17, s[20:23], s55 offen  lds
    s_add_u32 m0, s58, 19456
    s_add_u32 s55, s73, 2195456
    buffer_load_dwordx4 v17, s[20:23], s55 offen  lds
    s_add_u32 m0, s58, 20480
    s_add_u32 s55, s73, 2228224
    buffer_load_dwordx4 v16, s[20:23], s55 offen  lds
    s_add_u32 m0, s58, 21504
    s_add_u32 s55, s73, 2260992
    buffer_load_dwordx4 v16, s[20:23], s55 offen  lds
    s_add_u32 m0, s58, 22528
    s_add_u32 s55, s73, 2293760
    buffer_load_dwordx4 v17, s[20:23], s55 offen  lds
    s_add_u32 m0, s58, 23552
    s_add_u32 s55, s73, 2326528
    buffer_load_dwordx4 v17, s[20:23], s55 offen  lds
    s_waitcnt vmcnt(24)
    v_cmp_eq_u32 vcc, 0, v28
    s_cbranch_vccz L_q_rdy
    v_mov_b32 v12, 0
L_wf_4:
    buffer_load_dword v11, v12, s[8:11], 0 offen offset:16 sc1
    s_waitcnt vmcnt(0)
    v_cmp_ge_u32 vcc, 0, v11
    s_cbranch_vccz L_wfd_5
    s_sub_u32 s59, s59, 1
    s_cbranch_scc1 L_timeout
    s_sleep 2
    s_branch L_wf_4
L_wfd_5:
L_q_rdy:
    s_barrier
    ds_read_b64_tr_b16 a[68:69], v18 offset:24576
    ds_read_b64_tr_b16 a[70:71], v18 offset:25600
    ds_read_b64_tr_b16 a[76:77], v19 offset:24576
    ds_read_b64_tr_b16 a[78:79], v19 offset:25600
    ds_read_b64_tr_b16 a[84:85], v20 offset:24576
    ds_read_b64_tr_b16 a[86:87], v20 offset:25600
    ds_read_b64_tr_b16 a[92:93], v21 offset:24576
    ds_read_b64_tr_b16 a[94:95], v21 offset:25600
    ds_read_b64_tr_b16 a[100:101], v22 offset:24576
    ds_read_b64_tr_b16 a[102:103], v22 offset:25600
    ds_read_b64_tr_b16 a[108:109], v23 offset:24576
    ds_read_b64_tr_b16 a[110:111], v23 offset:25600
    s_waitcnt lgkmcnt(8)
    ds_read_b64_tr_b16 a[116:117], v24 offset:24576
    ds_read_b64_tr_b16 a[118:119], v24 offset:25600
    ds_read_b64_tr_b16 a[124:125], v25 offset:24576
    ds_read_b64_tr_b16 a[126:127], v25 offset:25600
    s_waitcnt lgkmcnt(0)
    s_barrier
    buffer_load_dwordx2 v[28:29], v31, s[4:7], s74 offen sc1
    s_add_u32 m0, s58, 24576
    s_add_u32 s55, s73, 2359296
    buffer_load_dwordx4 v16, s[20:23], s55 offen  lds
    s_add_u32 m0, s58, 25600
    s_add_u32 s55, s73, 2392064
    buffer_load_dwordx4 v16, s[20:23], s55 offen  lds
    s_add_u32 m0, s58, 26624
    s_add_u32 s55, s73, 2424832
    buffer_load_dwordx4 v17, s[20:23], s55 offen  lds
    s_add_u32 m0, s58, 27648
    s_add_u32 s55, s73, 2457600
    buffer_load_dwordx4 v17, s[20:23], s55 offen  lds
    s_add_u32 m0, s58, 28672
    s_add_u32 s55, s73, 2490368
    buffer_load_dwordx4 v16, s[20:23], s55 offen  lds
    s_add_u32 m0, s58, 29696
    s_add_u32 s55, s73, 2523136
    buffer_load_dwordx4 v16, s[20:23], s55 offen  lds
    s_add_u32 m0, s58, 30720
    s_add_u32 s55, s73, 2555904
    buffer_load_dwordx4 v17, s[20:23], s55 offen  lds
    s_add_u32 m0, s58, 31744
    s_add_u32 s55, s73, 2588672
    buffer_load_dwordx4 v17, s[20:23], s55 offen  lds
    s_waitcnt vmcnt(24)
    s_barrier
    ds_read_b64_tr_b16 a[128:129], v18 offset:0
    ds_read_b64_tr_b16 a[130:131], v18 offset:1024
    ds_read_b64_tr_b16 a[136:137], v19 offset:0
    ds_read_b64_tr_b16 a[138:139], v19 offset:1024
    ds_read_b64_tr_b16 a[144:145], v20 offset:0
    ds_read_b64_tr_b16 a[146:147], v20 offset:1024
    ds_read_b64_tr_b16 a[152:153], v21 offset:0
    ds_read_b64_tr_b16 a[154:155], v21 offset:1024
    ds_read_b64_tr_b16 a[160:161], v22 offset:0
    ds_read_b64_tr_b16 a[162:163], v22 offset:1024
    ds_read_b64_tr_b16 a[168:169], v23 offset:0
    ds_read_b64_tr_b16 a[170:171], v23 offset:1024
    s_waitcnt lgkmcnt(8)
    ds_read_b64_tr_b16 a[176:177], v24 offset:0
    ds_read_b64_tr_b16 a[178:179], v24 offset:1024
    ds_read_b64_tr_b16 a[184:185], v25 offset:0
    ds_read_b64_tr_b16 a[186:187], v25 offset:1024
    s_waitcnt lgkmcnt(0)
    s_waitcnt vmcnt(16)
    s_barrier
    ds_read_b64_tr_b16 a[132:133], v18 offset:8192
    ds_read_b64_tr_b16 a[134:135], v18 offset:9216
    ds_read_b64_tr_b16 a[140:141], v19 offset:8192
    ds_read_b64_tr_b16 a[142:143], v19 offset:9216
    ds_read_b64_tr_b16 a[148:149], v20 offset:8192
    ds_read_b64_tr_b16 a[150:151], v20 offset:9216
    ds_read_b64_tr_b16 a[156:157], v21 offset:8192
    ds_read_b64_tr_b16 a[158:159], v21 offset:9216
    ds_read_b64_tr_b16 a[164:165], v22 offset:8192
    ds_read_b64_tr_b16 a[166:167], v22 offset:9216
    ds_read_b64_tr_b16 a[172:173], v23 offset:8192
    ds_read_b64_tr_b16 a[174:175], v23 offset:9216
    s_waitcnt lgkmcnt(8)
    ds_read_b64_tr_b16 a[180:181], v24 offset:8192
    ds_read_b64_tr_b16 a[182:183], v24 offset:9216
    ds_read_b64_tr_b16 a[188:189], v25 offset:8192
    ds_read_b64_tr_b16 a[190:191], v25 offset:9216
    s_waitcnt lgkmcnt(0)
    s_waitcnt vmcnt(8)
    v_min_u32 v28, v28, v29
    v_cmp_eq_u32 vcc, 0, v28
    s_cbranch_vccz L_q_xn
    v_lshlrev_b32 v12, 2, v8
    s_mov_b32 s56, 0
L_wf_6:
    buffer_load_dword v11, v12, s[4:7], s56 offen offset:0 sc1
    s_waitcnt vmcnt(0)
    v_cmp_ge_u32 vcc, 0, v11
    s_cbranch_vccz L_wfd_7
    s_sub_u32 s59, s59, 1
    s_cbranch_scc1 L_timeout
    s_sleep 2
    s_branch L_wf_6
L_wfd_7:
L_wf_8:
    buffer_load_dword v11, v12, s[4:7], s56 offen offset:256 sc1
    s_waitcnt vmcnt(0)
    v_cmp_ge_u32 vcc, 0, v11
    s_cbranch_vccz L_wfd_9
    s_sub_u32 s59, s59, 1
    s_cbranch_scc1 L_timeout
    s_sleep 2
    s_branch L_wf_8
L_wfd_9:
L_q_xn:
    s_add_u32 m0, s65, 0
    s_add_u32 s55, s64, 0
    buffer_load_dwordx4 v1, s[4:7], s55 offen sc1 lds
    buffer_load_dwordx4 v1, s[4:7], s55 offen offset:1024 sc1 lds
    buffer_load_dwordx4 v1, s[4:7], s55 offen offset:2048 sc1 lds
    buffer_load_dwordx4 v1, s[4:7], s55 offen offset:3072 sc1 lds
    s_add_u32 m0, s65, 4096
    s_add_u32 s55, s64, 4096
    buffer_load_dwordx4 v1, s[4:7], s55 offen sc1 lds
    buffer_load_dwordx4 v1, s[4:7], s55 offen offset:1024 sc1 lds
    buffer_load_dwordx4 v1, s[4:7], s55 offen offset:2048 sc1 lds
    buffer_load_dwordx4 v1, s[4:7], s55 offen offset:3072 sc1 lds
    s_barrier
    ds_read_b64_tr_b16 a[192:193], v18 offset:16384
    ds_read_b64_tr_b16 a[194:195], v18 offset:17408
    ds_read_b64_tr_b16 a[200:201], v19 offset:16384
    ds_read_b64_tr_b16 a[202:203], v19 offset:17408
    ds_read_b64_tr_b16 a[208:209], v20 offset:16384
    ds_read_b64_tr_b16 a[210:211], v20 offset:17408
    ds_read_b64_tr_b16 a[216:217], v21 offset:16384
    ds_read_b64_tr_b16 a[218:219], v21 offset:17408
    ds_read_b64_tr_b16 a[224:225], v22 offset:16384
    ds_read_b64_tr_b16 a[226:227], v22 offset:17408
    ds_read_b64_tr_b16 a[232:233], v23 offset:16384
    ds_read_b64_tr_b16 a[234:235], v23 offset:17408
    s_waitcnt lgkmcnt(8)
    ds_read_b64_tr_b16 a[240:241], v24 offset:16384
    ds_read_b64_tr_b16 a[242:243], v24 offset:17408
    ds_read_b64_tr_b16 a[248:249], v25 offset:16384
    ds_read_b64_tr_b16 a[250:251], v25 offset:17408
    s_waitcnt lgkmcnt(0)
    s_waitcnt vmcnt(8)
    s_barrier
    ds_read_b64_tr_b16 a[196:197], v18 offset:24576
    ds_read_b64_tr_b16 a[198:199], v18 offset:25600
    ds_read_b64_tr_b16 a[204:205], v19 offset:24576
    ds_read_b64_tr_b16 a[206:207], v19 offset:25600
    ds_read_b64_tr_b16 a[212:213], v20 offset:24576
    ds_read_b64_tr_b16 a[214:215], v20 offset:25600
    ds_read_b64_tr_b16 a[220:221], v21 offset:24576
    ds_read_b64_tr_b16 a[222:223], v21 offset:25600
    ds_read_b64_tr_b16 a[228:229], v22 offset:24576
    ds_read_b64_tr_b16 a[230:231], v22 offset:25600
    ds_read_b64_tr_b16 a[236:237], v23 offset:24576
    ds_read_b64_tr_b16 a[238:239], v23 offset:25600
    s_waitcnt lgkmcnt(8)
    ds_read_b64_tr_b16 a[244:245], v24 offset:24576
    ds_read_b64_tr_b16 a[246:247], v24 offset:25600
    ds_read_b64_tr_b16 a[252:253], v25 offset:24576
    ds_read_b64_tr_b16 a[254:255], v25 offset:25600
    s_waitcnt lgkmcnt(0)
    s_waitcnt vmcnt(0)
    s_barrier
    s_mov_b32 s74, s66
    s_mov_b32 s98, -1
L_q_loop:
    s_cmp_ge_u32 s62, 64
    s_cbranch_scc1 L_q_att
    s_add_u32 s64, s64, 98304
    s_xor_b32 s65, s65, 0x20000
    ds_read_b128 v[64:67], v3 offset:0
    ds_read_b128 v[68:71], v3 offset:16384
    ds_read_b128 v[72:75], v3 offset:1024
    ds_read_b128 v[76:79], v3 offset:17408
    s_waitcnt lgkmcnt(2)
    v_mfma_f32_16x16x32_bf16 v[16:19], v[128:131], v[64:67], 0
    ds_read_b128 v[80:83], v3 offset:2048
    v_mfma_f32_16x16x32_bf16 v[20:23], v[128:131], v[68:71], 0
    ds_read_b128 v[84:87], v3 offset:18432
    v_mfma_f32_16x16x32_bf16 v[24:27], v[136:139], v[64:67], 0
    v_mfma_f32_16x16x32_bf16 v[28:31], v[136:139], v[68:71], 0
    v_mfma_f32_16x16x32_bf16 v[32:35], v[64:67], a[0:3], 0
    s_add_u32 m0, s65, 0
    s_add_u32 s55, s64, 0
    buffer_load_dwordx4 v1, s[4:7], s55 offen sc1 lds
    v_mfma_f32_16x16x32_bf16 v[36:39], v[68:71], a[0:3], 0
    v_mfma_f32_16x16x32_bf16 v[40:43], v[64:67], a[8:11], 0
    v_mfma_f32_16x16x32_bf16 v[44:47], v[68:71], a[8:11], 0
    v_mfma_f32_16x16x32_bf16 v[48:51], a[128:131], v[64:67], 0
    v_mfma_f32_16x16x32_bf16 v[52:55], a[128:131], v[68:71], 0
    v_mfma_f32_16x16x32_bf16 v[56:59], a[136:139], v[64:67], 0
    v_mfma_f32_16x16x32_bf16 v[60:63], a[136:139], v[68:71], 0
    s_waitcnt lgkmcnt(2)
    v_mfma_f32_16x16x32_bf16 v[16:19], v[132:135], v[72:75], v[16:19]
    ds_read_b128 v[64:67], v3 offset:3072
    v_mfma_f32_16x16x32_bf16 v[20:23], v[132:135], v[76:79], v[20:23]
    ds_read_b128 v[68:71], v3 offset:19456
    v_mfma_f32_16x16x32_bf16 v[24:27], v[140:143], v[72:75], v[24:27]
    v_mfma_f32_16x16x32_bf16 v[28:31], v[140:143], v[76:79], v[28:31]
    v_mfma_f32_16x16x32_bf16 v[32:35], v[72:75], a[4:7], v[32:35]
    buffer_load_dwordx4 v1, s[4:7], s55 offen offset:1024 sc1 lds
    v_mfma_f32_16x16x32_bf16 v[36:39], v[76:79], a[4:7], v[36:39]
    v_mfma_f32_16x16x32_bf16 v[40:43], v[72:75], a[12:15], v[40:43]
    v_mfma_f32_16x16x32_bf16 v[44:47], v[76:79], a[12:15], v[44:47]
    v_mfma_f32_16x16x32_bf16 v[48:51], a[132:135], v[72:75], v[48:51]
    v_mfma_f32_16x16x32_bf16 v[52:55], a[132:135], v[76:79], v[52:55]
    v_mfma_f32_16x16x32_bf16 v[56:59], a[140:143], v[72:75], v[56:59]
    v_mfma_f32_16x16x32_bf16 v[60:63], a[140:143], v[76:79], v[60:63]
    s_waitcnt lgkmcnt(2)
    v_mfma_f32_16x16x32_bf16 v[16:19], v[144:147], v[80:83], v[16:19]
    ds_read_b128 v[72:75], v3 offset:4096
    v_mfma_f32_16x16x32_bf16 v[20:23], v[144:147], v[84:87], v[20:23]
    ds_read_b128 v[76:79], v3 offset:20480
    v_mfma_f32_16x16x32_bf16 v[24:27], v[152:155], v[80:83], v[24:27]
    v_mfma_f32_16x16x32_bf16 v[28:31], v[152:155], v[84:87], v[28:31]
    v_mfma_f32_16x16x32_bf16 v[32:35], v[80:83], a[16:19], v[32:35]
    buffer_load_dwordx4 v1, s[4:7], s55 offen offset:2048 sc1 lds
    v_mfma_f32_16x16x32_bf16 v[36:39], v[84:87], a[16:19], v[36:39]
    v_mfma_f32_16x16x32_bf16 v[40:43], v[80:83], a[24:27], v[40:43]
    v_mfma_f32_16x16x32_bf16 v[44:47], v[84:87], a[24:27], v[44:47]
    v_mfma_f32_16x16x32_bf16 v[48:51], a[144:147], v[80:83], v[48:51]
    v_mfma_f32_16x16x32_bf16 v[52:55], a[144:147], v[84:87], v[52:55]
    v_mfma_f32_16x16x32_bf16 v[56:59], a[152:155], v[80:83], v[56:59]
    v_mfma_f32_16x16x32_bf16 v[60:63], a[152:155], v[84:87], v[60:63]
    s_waitcnt lgkmcnt(2)
    v_mfma_f32_16x16x32_bf16 v[16:19], v[148:151], v[64:67], v[16:19]
    ds_read_b128 v[80:83], v3 offset:5120
    v_mfma_f32_16x16x32_bf16 v[20:23], v[148:151], v[68:71], v[20:23]
    ds_read_b128 v[84:87], v3 offset:21504
    v_mfma_f32_16x16x32_bf16 v[24:27], v[156:159], v[64:67], v[24:27]
    v_mfma_f32_16x16x32_bf16 v[28:31], v[156:159], v[68:71], v[28:31]
    v_mfma_f32_16x16x32_bf16 v[32:35], v[64:67], a[20:23], v[32:35]
    buffer_load_dwordx4 v1, s[4:7], s55 offen offset:3072 sc1 lds
    v_mfma_f32_16x16x32_bf16 v[36:39], v[68:71], a[20:23], v[36:39]
    v_mfma_f32_16x16x32_bf16 v[40:43], v[64:67], a[28:31], v[40:43]
    v_mfma_f32_16x16x32_bf16 v[44:47], v[68:71], a[28:31], v[44:47]
    v_mfma_f32_16x16x32_bf16 v[48:51], a[148:151], v[64:67], v[48:51]
    v_mfma_f32_16x16x32_bf16 v[52:55], a[148:151], v[68:71], v[52:55]
    v_mfma_f32_16x16x32_bf16 v[56:59], a[156:159], v[64:67], v[56:59]
    v_mfma_f32_16x16x32_bf16 v[60:63], a[156:159], v[68:71], v[60:63]
    s_waitcnt lgkmcnt(2)
    v_mfma_f32_16x16x32_bf16 v[16:19], v[160:163], v[72:75], v[16:19]
    ds_read_b128 v[64:67], v3 offset:6144
    v_mfma_f32_16x16x32_bf16 v[20:23], v[160:163], v[76:79], v[20:23]
    ds_read_b128 v[68:71], v3 offset:22528
    v_mfma_f32_16x16x32_bf16 v[24:27], v[168:171], v[72:75], v[24:27]
    v_mfma_f32_16x16x32_bf16 v[28:31], v[168:171], v[76:79], v[28:31]
    v_mfma_f32_16x16x32_bf16 v[32:35], v[72:75], a[32:35], v[32:35]
    s_waitcnt vmcnt(8)
    v_mov_b32 v11, s77
    v_mov_b32 v12, 0
    s_mov_b64 exec, 1
    buffer_store_dword v11, v12, s[4:7], s71 offen sc1
    s_mov_b64 exec, -1
    v_mfma_f32_16x16x32_bf16 v[36:39], v[76:79], a[32:35], v[36:39]
    v_mfma_f32_16x16x32_bf16 v[40:43], v[72:75], a[40:43], v[40:43]
    v_mfma_f32_16x16x32_bf16 v[44:47], v[76:79], a[40:43], v[44:47]
    v_mfma_f32_16x16x32_bf16 v[48:51], a[160:163], v[72:75], v[48:51]
    v_mfma_f32_16x16x32_bf16 v[52:55], a[160:163], v[76:79], v[52:55]
    v_mfma_f32_16x16x32_bf16 v[56:59], a[168:171], v[72:75], v[56:59]
    v_mfma_f32_16x16x32_bf16 v[60:63], a[168:171], v[76:79], v[60:63]
    s_waitcnt lgkmcnt(2)
    v_mfma_f32_16x16x32_bf16 v[16:19], v[164:167], v[80:83], v[16:19]
    ds_read_b128 v[72:75], v3 offset:7168
    v_mfma_f32_16x16x32_bf16 v[20:23], v[164:167], v[84:87], v[20:23]
    ds_read_b128 v[76:79], v3 offset:23552
    v_mfma_f32_16x16x32_bf16 v[24:27], v[172:175], v[80:83], v[24:27]
    v_mfma_f32_16x16x32_bf16 v[28:31], v[172:175], v[84:87], v[28:31]
    v_mfma_f32_16x16x32_bf16 v[32:35], v[80:83], a[36:39], v[32:35]
    s_add_u32 m0, s65, 4096
    s_add_u32 s55, s64, 4096
    buffer_load_dwordx4 v1, s[4:7], s55 offen sc1 lds
    v_mfma_f32_16x16x32_bf16 v[36:39], v[84:87], a[36:39], v[36:39]
    v_mfma_f32_16x16x32_bf16 v[40:43], v[80:83], a[44:47], v[40:43]
    v_mfma_f32_16x16x32_bf16 v[44:47], v[84:87], a[44:47], v[44:47]
    v_mfma_f32_16x16x32_bf16 v[48:51], a[164:167], v[80:83], v[48:51]
    v_mfma_f32_16x16x32_bf16 v[52:55], a[164:167], v[84:87], v[52:55]
    v_mfma_f32_16x16x32_bf16 v[56:59], a[172:175], v[80:83], v[56:59]
    v_mfma_f32_16x16x32_bf16 v[60:63], a[172:175], v[84:87], v[60:63]
    s_waitcnt lgkmcnt(2)
    v_mfma_f32_16x16x32_bf16 v[16:19], v[176:179], v[64:67], v[16:19]
    ds_read_b128 v[80:83], v3 offset:8192
    v_mfma_f32_16x16x32_bf16 v[20:23], v[176:179], v[68:71], v[20:23]
    ds_read_b128 v[84:87], v3 offset:24576
    v_mfma_f32_16x16x32_bf16 v[24:27], v[184:187], v[64:67], v[24:27]
    v_mfma_f32_16x16x32_bf16 v[28:31], v[184:187], v[68:71], v[28:31]
    v_mfma_f32_16x16x32_bf16 v[32:35], v[64:67], a[48:51], v[32:35]
    buffer_load_dwordx4 v1, s[4:7], s55 offen offset:1024 sc1 lds
    v_mfma_f32_16x16x32_bf16 v[36:39], v[68:71], a[48:51], v[36:39]
    v_mfma_f32_16x16x32_bf16 v[40:43], v[64:67], a[56:59], v[40:43]
    v_mfma_f32_16x16x32_bf16 v[44:47], v[68:71], a[56:59], v[44:47]
    v_mfma_f32_16x16x32_bf16 v[48:51], a[176:179], v[64:67], v[48:51]
    v_mfma_f32_16x16x32_bf16 v[52:55], a[176:179], v[68:71], v[52:55]
    v_mfma_f32_16x16x32_bf16 v[56:59], a[184:187], v[64:67], v[56:59]
    v_mfma_f32_16x16x32_bf16 v[60:63], a[184:187], v[68:71], v[60:63]
    s_waitcnt lgkmcnt(2)
    v_mfma_f32_16x16x32_bf16 v[16:19], v[180:183], v[72:75], v[16:19]
    ds_read_b128 v[64:67], v3 offset:9216
    v_mfma_f32_16x16x32_bf16 v[20:23], v[180:183], v[76:79], v[20:23]
    ds_read_b128 v[68:71], v3 offset:25600
    v_mfma_f32_16x16x32_bf16 v[24:27], v[188:191], v[72:75], v[24:27]
    v_mfma_f32_16x16x32_bf16 v[28:31], v[188:191], v[76:79], v[28:31]
    v_mfma_f32_16x16x32_bf16 v[32:35], v[72:75], a[52:55], v[32:35]
    buffer_load_dwordx4 v1, s[4:7], s55 offen offset:2048 sc1 lds
    v_mfma_f32_16x16x32_bf16 v[36:39], v[76:79], a[52:55], v[36:39]
    v_mfma_f32_16x16x32_bf16 v[40:43], v[72:75], a[60:63], v[40:43]
    v_mfma_f32_16x16x32_bf16 v[44:47], v[76:79], a[60:63], v[44:47]
    v_mfma_f32_16x16x32_bf16 v[48:51], a[180:183], v[72:75], v[48:51]
    v_mfma_f32_16x16x32_bf16 v[52:55], a[180:183], v[76:79], v[52:55]
    v_mfma_f32_16x16x32_bf16 v[56:59], a[188:191], v[72:75], v[56:59]
    v_mfma_f32_16x16x32_bf16 v[60:63], a[188:191], v[76:79], v[60:63]
    s_waitcnt lgkmcnt(2)
    v_mfma_f32_16x16x32_bf16 v[16:19], v[192:195], v[80:83], v[16:19]
    ds_read_b128 v[72:75], v3 offset:10240
    v_mfma_f32_16x16x32_bf16 v[20:23], v[192:195], v[84:87], v[20:23]
    ds_read_b128 v[76:79], v3 offset:26624
    v_mfma_f32_16x16x32_bf16 v[24:27], v[200:203], v[80:83], v[24:27]
    v_mfma_f32_16x16x32_bf16 v[28:31], v[200:203], v[84:87], v[28:31]
    v_mfma_f32_16x16x32_bf16 v[32:35], v[80:83], a[64:67], v[32:35]
    buffer_load_dwordx4 v1, s[4:7], s55 offen offset:3072 sc1 lds
    v_mfma_f32_16x16x32_bf16 v[36:39], v[84:87], a[64:67], v[36:39]
    v_mfma_f32_16x16x32_bf16 v[40:43], v[80:83], a[72:75], v[40:43]
    v_mfma_f32_16x16x32_bf16 v[44:47], v[84:87], a[72:75], v[44:47]
    v_mfma_f32_16x16x32_bf16 v[48:51], a[192:195], v[80:83], v[48:51]
    v_mfma_f32_16x16x32_bf16 v[52:55], a[192:195], v[84:87], v[52:55]
    v_mfma_f32_16x16x32_bf16 v[56:59], a[200:203], v[80:83], v[56:59]
    v_mfma_f32_16x16x32_bf16 v[60:63], a[200:203], v[84:87], v[60:63]
    s_waitcnt lgkmcnt(2)
    v_mfma_f32_16x16x32_bf16 v[16:19], v[196:199], v[64:67], v[16:19]
    ds_read_b128 v[80:83], v3 offset:11264
    v_mfma_f32_16x16x32_bf16 v[20:23], v[196:199], v[68:71], v[20:23]
    ds_read_b128 v[84:87], v3 offset:27648
    v_mfma_f32_16x16x32_bf16 v[24:27], v[204:207], v[64:67], v[24:27]
    v_mfma_f32_16x16x32_bf16 v[28:31], v[204:207], v[68:71], v[28:31]
    v_mfma_f32_16x16x32_bf16 v[32:35], v[64:67], a[68:71], v[32:35]
    s_cmp_eq_u32 s98, -1
    s_cbranch_scc1 L_q_nofetch
    buffer_load_dwordx4 v[112:115], v1, s[4:7], s74 offen sc1
L_q_nofetch:
    v_mfma_f32_16x16x32_bf16 v[36:39], v[68:71], a[68:71], v[36:39]
    v_mfma_f32_16x16x32_bf16 v[40:43], v[64:67], a[76:79], v[40:43]
    v_mfma_f32_16x16x32_bf16 v[44:47], v[68:71], a[76:79], v[44:47]
    v_mfma_f32_16x16x32_bf16 v[48:51], a[196:199], v[64:67], v[48:51]
    v_mfma_f32_16x16x32_bf16 v[52:55], a[196:199], v[68:71], v[52:55]
    v_mfma_f32_16x16x32_bf16 v[56:59], a[204:207], v[64:67], v[56:59]
    v_mfma_f32_16x16x32_bf16 v[60:63], a[204:207], v[68:71], v[60:63]
    s_waitcnt lgkmcnt(2)
    v_mfma_f32_16x16x32_bf16 v[16:19], v[208:211], v[72:75], v[16:19]
    ds_read_b128 v[64:67], v3 offset:12288
    v_mfma_f32_16x16x32_bf16 v[20:23], v[208:211], v[76:79], v[20:23]
    ds_read_b128 v[68:71], v3 offset:28672
    v_mfma_f32_16x16x32_bf16 v[24:27], v[216:219], v[72:75], v[24:27]
    v_mfma_f32_16x16x32_bf16 v[28:31], v[216:219], v[76:79], v[28:31]
    v_mfma_f32_16x16x32_bf16 v[32:35], v[72:75], a[80:83], v[32:35]
    v_mfma_f32_16x16x32_bf16 v[36:39], v[76:79], a[80:83], v[36:39]
    v_mfma_f32_16x16x32_bf16 v[40:43], v[72:75], a[88:91], v[40:43]
    v_mfma_f32_16x16x32_bf16 v[44:47], v[76:79], a[88:91], v[44:47]
    v_mfma_f32_16x16x32_bf16 v[48:51], a[208:211], v[72:75], v[48:51]
    v_mfma_f32_16x16x32_bf16 v[52:55], a[208:211], v[76:79], v[52:55]
    v_mfma_f32_16x16x32_bf16 v[56:59], a[216:219], v[72:75], v[56:59]
    v_mfma_f32_16x16x32_bf16 v[60:63], a[216:219], v[76:79], v[60:63]
    s_waitcnt lgkmcnt(2)
    v_mfma_f32_16x16x32_bf16 v[16:19], v[212:215], v[80:83], v[16:19]
    ds_read_b128 v[72:75], v3 offset:13312
    v_mfma_f32_16x16x32_bf16 v[20:23], v[212:215], v[84:87], v[20:23]
    ds_read_b128 v[76:79], v3 offset:29696
    v_mfma_f32_16x16x32_bf16 v[24:27], v[220:223], v[80:83], v[24:27]
    v_mfma_f32_16x16x32_bf16 v[28:31], v[220:223], v[84:87], v[28:31]
    v_mfma_f32_16x16x32_bf16 v[32:35], v[80:83], a[84:87], v[32:35]
    v_mfma_f32_16x16x32_bf16 v[36:39], v[84:87], a[84:87], v[36:39]
    v_mfma_f32_16x16x32_bf16 v[40:43], v[80:83], a[92:95], v[40:43]
    v_mfma_f32_16x16x32_bf16 v[44:47], v[84:87], a[92:95], v[44:47]
    v_mfma_f32_16x16x32_bf16 v[48:51], a[212:215], v[80:83], v[48:51]
    v_mfma_f32_16x16x32_bf16 v[52:55], a[212:215], v[84:87], v[52:55]
    v_mfma_f32_16x16x32_bf16 v[56:59], a[220:223], v[80:83], v[56:59]
    v_mfma_f32_16x16x32_bf16 v[60:63], a[220:223], v[84:87], v[60:63]
    s_waitcnt lgkmcnt(2)
    v_mfma_f32_16x16x32_bf16 v[16:19], v[224:227], v[64:67], v[16:19]
    ds_read_b128 v[80:83], v3 offset:14336
    v_mfma_f32_16x16x32_bf16 v[20:23], v[224:227], v[68:71], v[20:23]
    ds_read_b128 v[84:87], v3 offset:30720
    v_mfma_f32_16x16x32_bf16 v[24:27], v[232:235], v[64:67], v[24:27]
    v_mfma_f32_16x16x32_bf16 v[28:31], v[232:235], v[68:71], v[28:31]
    v_mfma_f32_16x16x32_bf16 v[32:35], v[64:67], a[96:99], v[32:35]
    v_mfma_f32_16x16x32_bf16 v[36:39], v[68:71], a[96:99], v[36:39]
    v_mfma_f32_16x16x32_bf16 v[40:43], v[64:67], a[104:107], v[40:43]
    v_mfma_f32_16x16x32_bf16 v[44:47], v[68:71], a[104:107], v[44:47]
    v_mfma_f32_16x16x32_bf16 v[48:51], a[224:227], v[64:67], v[48:51]
    v_mfma_f32_16x16x32_bf16 v[52:55], a[224:227], v[68:71], v[52:55]
    v_mfma_f32_16x16x32_bf16 v[56:59], a[232:235], v[64:67], v[56:59]
    v_mfma_f32_16x16x32_bf16 v[60:63], a[232:235], v[68:71], v[60:63]
    s_waitcnt lgkmcnt(2)
    v_mfma_f32_16x16x32_bf16 v[16:19], v[228:231], v[72:75], v[16:19]
    ds_read_b128 v[64:67], v3 offset:15360
    v_mfma_f32_16x16x32_bf16 v[20:23], v[228:231], v[76:79], v[20:23]
    ds_read_b128 v[68:71], v3 offset:31744
    v_mfma_f32_16x16x32_bf16 v[24:27], v[236:239], v[72:75], v[24:27]
    v_mfma_f32_16x16x32_bf16 v[28:31], v[236:239], v[76:79], v[28:31]
    v_mfma_f32_16x16x32_bf16 v[32:35], v[72:75], a[100:103], v[32:35]
    v_mfma_f32_16x16x32_bf16 v[36:39], v[76:79], a[100:103], v[36:39]
    v_mfma_f32_16x16x32_bf16 v[40:43], v[72:75], a[108:111], v[40:43]
    v_mfma_f32_16x16x32_bf16 v[44:47], v[76:79], a[108:111], v[44:47]
    v_mfma_f32_16x16x32_bf16 v[48:51], a[228:231], v[72:75], v[48:51]
    v_mfma_f32_16x16x32_bf16 v[52:55], a[228:231], v[76:79], v[52:55]
    v_mfma_f32_16x16x32_bf16 v[56:59], a[236:239], v[72:75], v[56:59]
    v_mfma_f32_16x16x32_bf16 v[60:63], a[236:239], v[76:79], v[60:63]
    s_waitcnt lgkmcnt(2)
    v_mfma_f32_16x16x32_bf16 v[16:19], v[240:243], v[80:83], v[16:19]
    v_mfma_f32_16x16x32_bf16 v[20:23], v[240:243], v[84:87], v[20:23]
    v_mfma_f32_16x16x32_bf16 v[24:27], v[248:251], v[80:83], v[24:27]
    v_mfma_f32_16x16x32_bf16 v[28:31], v[248:251], v[84:87], v[28:31]
    v_mfma_f32_16x16x32_bf16 v[32:35], v[80:83], a[112:115], v[32:35]
    v_mfma_f32_16x16x32_bf16 v[36:39], v[84:87], a[112:115], v[36:39]
    v_mfma_f32_16x16x32_bf16 v[40:43], v[80:83], a[120:123], v[40:43]
    v_mfma_f32_16x16x32_bf16 v[44:47], v[84:87], a[120:123], v[44:47]
    v_mfma_f32_16x16x32_bf16 v[48:51], a[240:243], v[80:83], v[48:51]
    v_mfma_f32_16x16x32_bf16 v[52:55], a[240:243], v[84:87], v[52:55]
    v_mfma_f32_16x16x32_bf16 v[56:59], a[248:251], v[80:83], v[56:59]
    v_mfma_f32_16x16x32_bf16 v[60:63], a[248:251], v[84:87], v[60:63]
    s_waitcnt lgkmcnt(0)
    v_mfma_f32_16x16x32_bf16 v[16:19], v[244:247], v[64:67], v[16:19]
    v_mfma_f32_16x16x32_bf16 v[20:23], v[244:247], v[68:71], v[20:23]
    v_mfma_f32_16x16x32_bf16 v[24:27], v[252:255], v[64:67], v[24:27]
    v_mfma_f32_16x16x32_bf16 v[28:31], v[252:255], v[68:71], v[28:31]
    v_mfma_f32_16x16x32_bf16 v[32:35], v[64:67], a[116:119], v[32:35]
    v_mfma_f32_16x16x32_bf16 v[36:39], v[68:71], a[116:119], v[36:39]
    v_mfma_f32_16x16x32_bf16 v[40:43], v[64:67], a[124:127], v[40:43]
    v_mfma_f32_16x16x32_bf16 v[44:47], v[68:71], a[124:127], v[44:47]
    v_mfma_f32_16x16x32_bf16 v[48:51], a[244:247], v[64:67], v[48:51]
    v_mfma_f32_16x16x32_bf16 v[52:55], a[244:247], v[68:71], v[52:55]
    v_mfma_f32_16x16x32_bf16 v[56:59], a[252:255], v[64:67], v[56:59]
    v_mfma_f32_16x16x32_bf16 v[60:63], a[252:255], v[68:71], v[60:63]
    s_lshl_b32 s56, s62, 15
    s_add_u32 s56, s56, s66
    s_lshl_b32 s57, s52, 9
    s_add_u32 s57, s57, s56
    s_lshl_b32 s55, s52, 10
    s_add_u32 s55, s55, s56
    s_add_u32 s73, s55, 16384
    s_lshl_b32 s55, s52, 12
    s_add_u32 s56, s56, s55
    v_mov_b64 v[64:65], -1
    v_mov_b64 v[66:67], -1
    buffer_store_dwordx4 v[64:67], v1, s[4:7], s73 offen sc1
    v_xor_b32 v3, 0x20000, v3
    v_mul_f32 v16, s67, v16
    v_mul_f32 v17, s67, v17
    v_mul_f32 v18, s67, v18
    v_mul_f32 v19, s67, v19
    v_mul_f32 v20, s67, v20
    v_mul_f32 v21, s67, v21
    v_mul_f32 v22, s67, v22
    v_mul_f32 v23, s67, v23
    v_mul_f32 v24, s67, v24
    v_mul_f32 v25, s67, v25
    v_mul_f32 v26, s67, v26
    v_mul_f32 v27, s67, v27
    v_mul_f32 v28, s67, v28
    v_mul_f32 v29, s67, v29
    v_mul_f32 v30, s67, v30
    v_mul_f32 v31, s67, v31
    v_cvt_pk_bf16_f32 v88, v16, v24
    v_cvt_pk_bf16_f32 v89, v17, v25
    v_cvt_pk_bf16_f32 v90, v18, v26
    v_cvt_pk_bf16_f32 v91, v19, v27
    buffer_store_dwordx4 v[88:91], v2, s[4:7], s57 offen sc1
    s_add_u32 s57, s57, 8192
    v_cvt_pk_bf16_f32 v92, v20, v28
    v_cvt_pk_bf16_f32 v93, v21, v29
    v_cvt_pk_bf16_f32 v94, v22, v30
    v_cvt_pk_bf16_f32 v95, v23, v31
    buffer_store_dwordx4 v[92:95], v2, s[4:7], s57 offen sc1
    s_add_u32 s57, s57, 8192
    v_cvt_pk_bf16_f32 v96, v32, v33
    v_cvt_pk_bf16_f32 v97, v34, v35
    v_cvt_pk_bf16_f32 v98, v36, v37
    v_cvt_pk_bf16_f32 v99, v38, v39
    buffer_store_dwordx4 v[96:99], v1, s[4:7], s56 offen offset:2048 sc1
    v_cvt_pk_bf16_f32 v100, v40, v41
    v_cvt_pk_bf16_f32 v101, v42, v43
    v_cvt_pk_bf16_f32 v102, v44, v45
    v_cvt_pk_bf16_f32 v103, v46, v47
    buffer_store_dwordx4 v[100:103], v1, s[4:7], s56 offen offset:3072 sc1
    s_and_b32 s55, s68, 7
    s_lshl_b32 s55, s55, 13
    s_lshl_b32 s57, s52, 10
    s_add_u32 s55, s55, s57
    s_add_u32 s55, s55, 65536
    v_add_u32 v4, s55, v1
    v_cvt_pk_bf16_f32 v104, v48, v56
    v_cvt_pk_bf16_f32 v105, v49, v57
    v_cvt_pk_bf16_f32 v106, v50, v58
    v_cvt_pk_bf16_f32 v107, v51, v59
    ds_write_b128 v4, v[104:107] offset:0
    v_cvt_pk_bf16_f32 v108, v52, v60
    v_cvt_pk_bf16_f32 v109, v53, v61
    v_cvt_pk_bf16_f32 v110, v54, v62
    v_cvt_pk_bf16_f32 v111, v55, v63
    ds_write_b128 v4, v[108:111] offset:4096
    s_add_u32 s62, s62, 3
    s_add_u32 s68, s68, 1
    s_mov_b32 s3, 1
    s_cmp_ge_u32 s68, 7
    s_cbranch_scc1 L_q_att
    s_waitcnt vmcnt(0) lgkmcnt(0)
    s_barrier
    s_cmp_lg_u32 s52, 0
    s_cbranch_scc1 L_fs_10
    v_mov_b32 v11, s62
    v_mov_b32 v12, 0
    s_mov_b64 exec, 1
    buffer_store_dword v11, v12, s[4:7], s70 offen sc1
    s_mov_b64 exec, -1
L_fs_10:
    s_cmp_lg_u32 s68, 1
    s_cbranch_scc1 L_q_loop
    s_lshl_b32 s56, s63, 15
    s_add_u32 s56, s56, s66
    s_lshl_b32 s55, s52, 10
    s_add_u32 s74, s56, s55
    s_add_u32 s74, s74, 16384
    s_lshl_b32 s55, s52, 12
    s_add_u32 s56, s56, s55
    s_add_u32 m0, s55, 36864
    v_mov_b32 v112, -1
    buffer_load_dwordx4 v1, s[4:7], s56 offen offset:0 sc1 lds
    buffer_load_dwordx4 v1, s[4:7], s56 offen offset:1024 sc1 lds
    buffer_load_dwordx4 v1, s[4:7], s56 offen offset:2048 sc1 lds
    buffer_load_dwordx4 v1, s[4:7], s56 offen offset:3072 sc1 lds
    s_branch L_q_loop
L_q_att:
    s_and_b32 s55, s52, 1
    s_and_b32 s57, s69, 7
    s_lshl_b32 s57, s57, 13
    s_lshl_b32 s76, s75, 12
    s_add_u32 s57, s57, s76
    s_add_u32 s57, s57, 65536
    v_add_u32 v5, s57, v1
    s_lshl_b32 s73, s55, 13
    v_add_u32 v86, s73, v1
    s_lshl_b32 s73, s52, 10
    v_add_u32 v84, s73, v1
    s_lshl_b32 s73, s55, 7
    v_add_u32 v85, s73, v6
    v_mov_b32 v121, 0
    v_mov_b32 v122, 0
    v_mov_b32 v126, 0xff800000
    s_lshl_b32 s76, s63, 1
    s_add_u32 s76, s76, s75
    s_lshl_b32 s76, s76, 17
    s_lshl_b32 s57, s60, 12
    s_add_u32 s76, s76, s57
    s_lshl_b32 s55, s55, 11
    s_add_u32 s76, s76, s55
    s_add_u32 s76, s76, 0x1000000
    s_cmp_lt_u32 s3, 1
    s_cbranch_scc1 L_a_nopj
    s_waitcnt vmcnt(5) lgkmcnt(0)
    s_branch L_a_pj
L_a_nopj:
    s_waitcnt vmcnt(0)
L_a_pj:
    s_mov_b32 s3, 0
    s_barrier
    ds_read_b128 v[48:51], v5 offset:0
    ds_read_b128 v[52:55], v5 offset:1024
    ds_read_b128 v[56:59], v5 offset:2048
    ds_read_b128 v[60:63], v5 offset:3072
    ds_read_b128 v[16:19], v2 offset:36864
    ds_read_b128 v[20:23], v2 offset:37376
    ds_read_b128 v[24:27], v2 offset:37888
    ds_read_b128 v[28:31], v2 offset:38400
    ds_read_b128 v[32:35], v2 offset:45056
    ds_read_b128 v[36:39], v2 offset:45568
    ds_read_b128 v[40:43], v2 offset:46080
    ds_read_b128 v[44:47], v2 offset:46592
    s_waitcnt lgkmcnt(4)
    ds_read_b128 v[64:67], v86 offset:38912
    ds_read_b128 v[68:71], v86 offset:39936
    ds_read_b128 v[72:75], v86 offset:43008
    ds_read_b128 v[76:79], v86 offset:44032
    s_waitcnt lgkmcnt(4)
    v_mfma_f32_16x16x32_bf16 v[100:103], v[16:19], v[48:51], 0
    v_mfma_f32_16x16x32_bf16 v[100:103], v[20:23], v[52:55], v[100:103]
    v_mfma_f32_16x16x32_bf16 v[100:103], v[24:27], v[56:59], v[100:103]
    v_mfma_f32_16x16x32_bf16 v[100:103], v[28:31], v[60:63], v[100:103]
    v_mfma_f32_16x16x32_bf16 v[104:107], v[32:35], v[48:51], 0
    v_mfma_f32_16x16x32_bf16 v[104:107], v[36:39], v[52:55], v[104:107]
    v_mfma_f32_16x16x32_bf16 v[104:107], v[40:43], v[56:59], v[104:107]
    v_mfma_f32_16x16x32_bf16 v[104:107], v[44:47], v[60:63], v[104:107]
    v_cndmask_b32 v100, v126, v100, s[78:79]
    v_cndmask_b32 v101, v126, v101, s[80:81]
    v_cndmask_b32 v102, v126, v102, s[82:83]
    v_cndmask_b32 v103, v126, v103, s[84:85]
    s_nop 3
    v_cndmask_b32 v104, v126, v104, s[86:87]
    v_cndmask_b32 v105, v126, v105, s[88:89]
    v_cndmask_b32 v106, v126, v106, s[90:91]
    v_cndmask_b32 v107, v126, v107, s[92:93]
    v_max3_f32 v124, v100, v101, v102
    v_max3_f32 v124, v124, v103, v104
    v_max3_f32 v124, v124, v105, v106
    v_max_f32 v124, v124, v107
    v_mov_b32 v36, 0x3f803f80
    v_mov_b32 v37, 0x3f803f80
    v_mov_b32 v38, 0x3f803f80
    v_mov_b32 v39, 0x3f803f80
    s_waitcnt vmcnt(0) lgkmcnt(0)
    s_barrier
    s_cmp_lg_u32 s52, 0
    s_cbranch_scc1 L_fs_11
    v_mov_b32 v11, s62
    v_mov_b32 v12, 0
    s_mov_b64 exec, 1
    buffer_store_dword v11, v12, s[4:7], s70 offen sc1
    s_mov_b64 exec, -1
L_fs_11:
L_a_poll:
    v_max3_u32 v11, v112, v113, v114
    v_max_u32 v11, v11, v115
    ds_write_b128 v84, v[112:115] offset:32768
    v_cmp_eq_u32 vcc, -1, v11
    s_cbranch_vccz L_a_go
    s_sub_u32 s59, s59, 1
    s_cbranch_scc1 L_timeout
    s_cmp_ge_u32 s63, 99
    s_cbranch_scc1 L_a_full
L_a_peek:
    s_load_dword s98, s[4:5], s74 glc
    s_waitcnt lgkmcnt(0)
    s_cmp_lg_u32 s98, -1
    s_cbranch_scc1 L_a_full
    s_sub_u32 s59, s59, 1
    s_cbranch_scc1 L_timeout
    s_sleep 1
    s_branch L_a_peek
L_a_full:
    buffer_load_dwordx4 v[112:115], v1, s[4:7], s74 offen sc1
    s_waitcnt vmcnt(0)
    s_branch L_a_poll
L_a_go:
    s_waitcnt lgkmcnt(0)
    s_barrier
    ds_read_b32 v96, v85 offset:34816
    ds_read_b32 v97, v85 offset:35072
    ds_read_b32 v98, v85 offset:34880
    ds_read_b32 v99, v85 offset:35136
    ds_read_b128 v[80:83], v7 offset:32768
    ds_read_b128 v[84:87], v7 offset:32832
    ds_read_b128 v[88:91], v7 offset:32896
    ds_read_b128 v[92:95], v7 offset:32960
    s_waitcnt lgkmcnt(0)
    s_add_u32 s57, s74, 98304
    s_load_dword s98, s[4:5], s57 glc
    v_mfma_f32_16x16x32_bf16 v[108:111], v[80:83], v[48:51], 0
    v_mfma_f32_16x16x32_bf16 v[108:111], v[84:87], v[52:55], v[108:111]
    v_mfma_f32_16x16x32_bf16 v[108:111], v[88:91], v[56:59], v[108:111]
    v_mfma_f32_16x16x32_bf16 v[108:111], v[92:95], v[60:63], v[108:111]
    s_nop 7
    v_mul_f32 v108, s67, v108
    v_mul_f32 v109, s67, v110
    v_max3_f32 v124, v124, v108, v109
    v_mov_b32 v125, v124
    s_nop 1
    v_permlane16_swap_b32 v124, v125
    v_max_f32 v124, v124, v125
    v_mov_b32 v125, v124
    s_nop 1
    v_permlane32_swap_b32 v124, v125
    v_max_f32 v124, v124, v125
    v_sub_f32 v100, v100, v124
    v_sub_f32 v101, v101, v124
    v_sub_f32 v102, v102, v124
    v_sub_f32 v103, v103, v124
    v_sub_f32 v104, v104, v124
    v_sub_f32 v105, v105, v124
    v_sub_f32 v106, v106, v124
    v_sub_f32 v107, v107, v124
    v_sub_f32 v108, v108, v124
    v_sub_f32 v109, v109, v124
    v_exp_f32 v100, v100
    v_exp_f32 v101, v101
    v_exp_f32 v102, v102
    v_exp_f32 v103, v103
    v_exp_f32 v104, v104
    v_exp_f32 v105, v105
    v_exp_f32 v106, v106
    v_exp_f32 v107, v107
    v_exp_f32 v108, v108
    v_exp_f32 v109, v109
    v_cvt_pk_bf16_f32 v116, v100, v101
    v_cvt_pk_bf16_f32 v117, v102, v103
    v_cvt_pk_bf16_f32 v118, v104, v105
    v_cvt_pk_bf16_f32 v119, v106, v107
    v_cvt_pk_bf16_f32 v120, v108, v109
    v_cvt_pk_bf16_f32 v123, v108, v109
    v_mfma_f32_16x16x32_bf16 v[32:35], v[36:39], v[116:119], 0
    v_mfma_f32_16x16x32_bf16 v[16:19], v[64:67], v[116:119], 0
    v_mfma_f32_16x16x32_bf16 v[20:23], v[68:71], v[116:119], 0
    v_mfma_f32_16x16x32_bf16 v[24:27], v[72:75], v[116:119], 0
    v_mfma_f32_16x16x32_bf16 v[28:31], v[76:79], v[116:119], 0
    v_mfma_f32_16x16x16_bf16 v[32:35], v[36:37], v[120:121], v[32:35]
    v_mfma_f32_16x16x16_bf16 v[16:19], v[96:97], v[120:121], v[16:19]
    v_mfma_f32_16x16x16_bf16 v[20:23], v[96:97], v[122:123], v[20:23]
    v_mfma_f32_16x16x16_bf16 v[24:27], v[98:99], v[120:121], v[24:27]
    v_mfma_f32_16x16x16_bf16 v[28:31], v[98:99], v[122:123], v[28:31]
    v_rcp_f32 v32, v32
    s_nop 0
    v_mul_f32 v16, v16, v32
    v_mul_f32 v17, v17, v32
    v_mul_f32 v18, v18, v32
    v_mul_f32 v19, v19, v32
    v_mul_f32 v20, v20, v32
    v_mul_f32 v21, v21, v32
    v_mul_f32 v22, v22, v32
    v_mul_f32 v23, v23, v32
    v_cvt_pk_bf16_f32 v48, v16, v17
    v_cvt_pk_bf16_f32 v49, v18, v19
    v_cvt_pk_bf16_f32 v50, v20, v21
    v_cvt_pk_bf16_f32 v51, v22, v23
    buffer_store_dwordx4 v[48:51], v1, s[4:7], s76 offen offset:0 sc1
    v_mul_f32 v24, v24, v32
    v_mul_f32 v25, v25, v32
    v_mul_f32 v26, v26, v32
    v_mul_f32 v27, v27, v32
    v_mul_f32 v28, v28, v32
    v_mul_f32 v29, v29, v32
    v_mul_f32 v30, v30, v32
    v_mul_f32 v31, v31, v32
    v_cvt_pk_bf16_f32 v52, v24, v25
    v_cvt_pk_bf16_f32 v53, v26, v27
    v_cvt_pk_bf16_f32 v54, v28, v29
    v_cvt_pk_bf16_f32 v55, v30, v31
    buffer_store_dwordx4 v[52:55], v1, s[4:7], s76 offen offset:1024 sc1
    s_add_u32 s63, s63, 3
    s_add_u32 s69, s69, 1
    s_mov_b32 s77, s63
    s_waitcnt lgkmcnt(0)
    s_cmp_lt_u32 s62, 64
    s_cbranch_scc1 L_a_defer
    s_waitcnt vmcnt(0)
    v_mov_b32 v11, s77
    v_mov_b32 v12, 0
    s_mov_b64 exec, 1
    buffer_store_dword v11, v12, s[4:7], s71 offen sc1
    s_mov_b64 exec, -1
L_a_defer:
    s_cmp_ge_u32 s63, 64
    s_cbranch_scc1 L_end
    s_lshl_b32 s56, s63, 15
    s_add_u32 s56, s56, s66
    s_lshl_b32 s55, s52, 10
    s_add_u32 s74, s56, s55
    s_add_u32 s74, s74, 16384
    s_lshl_b32 s55, s52, 12
    s_add_u32 s56, s56, s55
    s_add_u32 m0, s55, 36864
    v_mov_b32 v112, -1
    buffer_load_dwordx4 v1, s[4:7], s56 offen offset:0 sc1 lds
    buffer_load_dwordx4 v1, s[4:7], s56 offen offset:1024 sc1 lds
    buffer_load_dwordx4 v1, s[4:7], s56 offen offset:2048 sc1 lds
    buffer_load_dwordx4 v1, s[4:7], s56 offen offset:3072 sc1 lds
    s_branch L_q_loop
L_ln:
    v_mov_b32 v8, v0
    v_lshrrev_b32 v9, 4, v8
    v_and_b32 v10, 15, v8
    v_lshlrev_b32 v1, 4, v8
    s_sub_u32 s60, s53, 224
    s_lshl_b32 s60, s60, 2
    s_add_u32 s60, s60, s52
    s_lshl_b32 s56, s60, 14
    v_lshlrev_b32 v11, 10, v10
    v_lshl_add_u32 v11, v9, 4, v11
    buffer_load_dwordx4 v[16:19], v11, s[12:15], s56 offen offset:0
    buffer_load_dwordx4 v[20:23], v11, s[12:15], s56 offen offset:64
    buffer_load_dwordx4 v[24:27], v11, s[12:15], s56 offen offset:128
    buffer_load_dwordx4 v[28:31], v11, s[12:15], s56 offen offset:192
    buffer_load_dwordx4 v[32:35], v11, s[12:15], s56 offen offset:256
    buffer_load_dwordx4 v[36:39], v11, s[12:15], s56 offen offset:320
    buffer_load_dwordx4 v[40:43], v11, s[12:15], s56 offen offset:384
    buffer_load_dwordx4 v[44:47], v11, s[12:15], s56 offen offset:448
    buffer_load_dwordx4 v[48:51], v11, s[12:15], s56 offen offset:512
    buffer_load_dwordx4 v[52:55], v11, s[12:15], s56 offen offset:576
    buffer_load_dwordx4 v[56:59], v11, s[12:15], s56 offen offset:640
    buffer_load_dwordx4 v[60:63], v11, s[12:15], s56 offen offset:704
    buffer_load_dwordx4 v[64:67], v11, s[12:15], s56 offen offset:768
    buffer_load_dwordx4 v[68:71], v11, s[12:15], s56 offen offset:832
    buffer_load_dwordx4 v[72:75], v11, s[12:15], s56 offen offset:896
    buffer_load_dwordx4 v[76:79], v11, s[12:15], s56 offen offset:960
    v_mov_b64 v[208:209], 0
    s_mov_b32 s61, 0xffff0000
    s_waitcnt vmcnt(15)
    v_lshlrev_b32 v80, 16, v16
    v_and_b32 v81, s61, v16
    v_pk_add_f32 v[208:209], v[208:209], v[80:81]
    v_lshlrev_b32 v82, 16, v17
    v_and_b32 v83, s61, v17
    v_pk_add_f32 v[208:209], v[208:209], v[82:83]
    v_lshlrev_b32 v84, 16, v18
    v_and_b32 v85, s61, v18
    v_pk_add_f32 v[208:209], v[208:209], v[84:85]
    v_lshlrev_b32 v86, 16, v19
    v_and_b32 v87, s61, v19
    v_pk_add_f32 v[208:209], v[208:209], v[86:87]
    s_waitcnt vmcnt(14)
    v_lshlrev_b32 v88, 16, v20
    v_and_b32 v89, s61, v20
    v_pk_add_f32 v[208:209], v[208:209], v[88:89]
    v_lshlrev_b32 v90, 16, v21
    v_and_b32 v91, s61, v21
    v_pk_add_f32 v[208:209], v[208:209], v[90:91]
    v_lshlrev_b32 v92, 16, v22
    v_and_b32 v93, s61, v22
    v_pk_add_f32 v[208:209], v[208:209], v[92:93]
    v_lshlrev_b32 v94, 16, v23
    v_and_b32 v95, s61, v23
    v_pk_add_f32 v[208:209], v[208:209], v[94:95]
    s_waitcnt vmcnt(13)
    v_lshlrev_b32 v96, 16, v24
    v_and_b32 v97, s61, v24
    v_pk_add_f32 v[208:209], v[208:209], v[96:97]
    v_lshlrev_b32 v98, 16, v25
    v_and_b32 v99, s61, v25
    v_pk_add_f32 v[208:209], v[208:209], v[98:99]
    v_lshlrev_b32 v100, 16, v26
    v_and_b32 v101, s61, v26
    v_pk_add_f32 v[208:209], v[208:209], v[100:101]
    v_lshlrev_b32 v102, 16, v27
    v_and_b32 v103, s61, v27
    v_pk_add_f32 v[208:209], v[208:209], v[102:103]
    s_waitcnt vmcnt(12)
    v_lshlrev_b32 v104, 16, v28
    v_and_b32 v105, s61, v28
    v_pk_add_f32 v[208:209], v[208:209], v[104:105]
    v_lshlrev_b32 v106, 16, v29
    v_and_b32 v107, s61, v29
    v_pk_add_f32 v[208:209], v[208:209], v[106:107]
    v_lshlrev_b32 v108, 16, v30
    v_and_b32 v109, s61, v30
    v_pk_add_f32 v[208:209], v[208:209], v[108:109]
    v_lshlrev_b32 v110, 16, v31
    v_and_b32 v111, s61, v31
    v_pk_add_f32 v[208:209], v[208:209], v[110:111]
    s_waitcnt vmcnt(11)
    v_lshlrev_b32 v112, 16, v32
    v_and_b32 v113, s61, v32
    v_pk_add_f32 v[208:209], v[208:209], v[112:113]
    v_lshlrev_b32 v114, 16, v33
    v_and_b32 v115, s61, v33
    v_pk_add_f32 v[208:209], v[208:209], v[114:115]
    v_lshlrev_b32 v116, 16, v34
    v_and_b32 v117, s61, v34
    v_pk_add_f32 v[208:209], v[208:209], v[116:117]
    v_lshlrev_b32 v118, 16, v35
    v_and_b32 v119, s61, v35
    v_pk_add_f32 v[208:209], v[208:209], v[118:119]
    s_waitcnt vmcnt(10)
    v_lshlrev_b32 v120, 16, v36
    v_and_b32 v121, s61, v36
    v_pk_add_f32 v[208:209], v[208:209], v[120:121]
    v_lshlrev_b32 v122, 16, v37
    v_and_b32 v123, s61, v37
    v_pk_add_f32 v[208:209], v[208:209], v[122:123]
    v_lshlrev_b32 v124, 16, v38
    v_and_b32 v125, s61, v38
    v_pk_add_f32 v[208:209], v[208:209], v[124:125]
    v_lshlrev_b32 v126, 16, v39
    v_and_b32 v127, s61, v39
    v_pk_add_f32 v[208:209], v[208:209], v[126:127]
    s_waitcnt vmcnt(9)
    v_lshlrev_b32 v128, 16, v40
    v_and_b32 v129, s61, v40
    v_pk_add_f32 v[208:209], v[208:209], v[128:129]
    v_lshlrev_b32 v130, 16, v41
    v_and_b32 v131, s61, v41
    v_pk_add_f32 v[208:209], v[208:209], v[130:131]
    v_lshlrev_b32 v132, 16, v42
    v_and_b32 v133, s61, v42
    v_pk_add_f32 v[208:209], v[208:209], v[132:133]
    v_lshlrev_b32 v134, 16, v43
    v_and_b32 v135, s61, v43
    v_pk_add_f32 v[208:209], v[208:209], v[134:135]
    s_waitcnt vmcnt(8)
    v_lshlrev_b32 v136, 16, v44
    v_and_b32 v137, s61, v44
    v_pk_add_f32 v[208:209], v[208:209], v[136:137]
    v_lshlrev_b32 v138, 16, v45
    v_and_b32 v139, s61, v45
    v_pk_add_f32 v[208:209], v[208:209], v[138:139]
    v_lshlrev_b32 v140, 16, v46
    v_and_b32 v141, s61, v46
    v_pk_add_f32 v[208:209], v[208:209], v[140:141]
    v_lshlrev_b32 v142, 16, v47
    v_and_b32 v143, s61, v47
    v_pk_add_f32 v[208:209], v[208:209], v[142:143]
    s_waitcnt vmcnt(7)
    v_lshlrev_b32 v144, 16, v48
    v_and_b32 v145, s61, v48
    v_pk_add_f32 v[208:209], v[208:209], v[144:145]
    v_lshlrev_b32 v146, 16, v49
    v_and_b32 v147, s61, v49
    v_pk_add_f32 v[208:209], v[208:209], v[146:147]
    v_lshlrev_b32 v148, 16, v50
    v_and_b32 v149, s61, v50
    v_pk_add_f32 v[208:209], v[208:209], v[148:149]
    v_lshlrev_b32 v150, 16, v51
    v_and_b32 v151, s61, v51
    v_pk_add_f32 v[208:209], v[208:209], v[150:151]
    s_waitcnt vmcnt(6)
    v_lshlrev_b32 v152, 16, v52
    v_and_b32 v153, s61, v52
    v_pk_add_f32 v[208:209], v[208:209], v[152:153]
    v_lshlrev_b32 v154, 16, v53
    v_and_b32 v155, s61, v53
    v_pk_add_f32 v[208:209], v[208:209], v[154:155]
    v_lshlrev_b32 v156, 16, v54
    v_and_b32 v157, s61, v54
    v_pk_add_f32 v[208:209], v[208:209], v[156:157]
    v_lshlrev_b32 v158, 16, v55
    v_and_b32 v159, s61, v55
    v_pk_add_f32 v[208:209], v[208:209], v[158:159]
    s_waitcnt vmcnt(5)
    v_lshlrev_b32 v160, 16, v56
    v_and_b32 v161, s61, v56
    v_pk_add_f32 v[208:209], v[208:209], v[160:161]
    v_lshlrev_b32 v162, 16, v57
    v_and_b32 v163, s61, v57
    v_pk_add_f32 v[208:209], v[208:209], v[162:163]
    v_lshlrev_b32 v164, 16, v58
    v_and_b32 v165, s61, v58
    v_pk_add_f32 v[208:209], v[208:209], v[164:165]
    v_lshlrev_b32 v166, 16, v59
    v_and_b32 v167, s61, v59
    v_pk_add_f32 v[208:209], v[208:209], v[166:167]
    s_waitcnt vmcnt(4)
    v_lshlrev_b32 v168, 16, v60
    v_and_b32 v169, s61, v60
    v_pk_add_f32 v[208:209], v[208:209], v[168:169]
    v_lshlrev_b32 v170, 16, v61
    v_and_b32 v171, s61, v61
    v_pk_add_f32 v[208:209], v[208:209], v[170:171]
    v_lshlrev_b32 v172, 16, v62
    v_and_b32 v173, s61, v62
    v_pk_add_f32 v[208:209], v[208:209], v[172:173]
    v_lshlrev_b32 v174, 16, v63
    v_and_b32 v175, s61, v63
    v_pk_add_f32 v[208:209], v[208:209], v[174:175]
    s_waitcnt vmcnt(3)
    v_lshlrev_b32 v176, 16, v64
    v_and_b32 v177, s61, v64
    v_pk_add_f32 v[208:209], v[208:209], v[176:177]
    v_lshlrev_b32 v178, 16, v65
    v_and_b32 v179, s61, v65
    v_pk_add_f32 v[208:209], v[208:209], v[178:179]
    v_lshlrev_b32 v180, 16, v66
    v_and_b32 v181, s61, v66
    v_pk_add_f32 v[208:209], v[208:209], v[180:181]
    v_lshlrev_b32 v182, 16, v67
    v_and_b32 v183, s61, v67
    v_pk_add_f32 v[208:209], v[208:209], v[182:183]
    s_waitcnt vmcnt(2)
    v_lshlrev_b32 v184, 16, v68
    v_and_b32 v185, s61, v68
    v_pk_add_f32 v[208:209], v[208:209], v[184:185]
    v_lshlrev_b32 v186, 16, v69
    v_and_b32 v187, s61, v69
    v_pk_add_f32 v[208:209], v[208:209], v[186:187]
    v_lshlrev_b32 v188, 16, v70
    v_and_b32 v189, s61, v70
    v_pk_add_f32 v[208:209], v[208:209], v[188:189]
    v_lshlrev_b32 v190, 16, v71
    v_and_b32 v191, s61, v71
    v_pk_add_f32 v[208:209], v[208:209], v[190:191]
    s_waitcnt vmcnt(1)
    v_lshlrev_b32 v192, 16, v72
    v_and_b32 v193, s61, v72
    v_pk_add_f32 v[208:209], v[208:209], v[192:193]
    v_lshlrev_b32 v194, 16, v73
    v_and_b32 v195, s61, v73
    v_pk_add_f32 v[208:209], v[208:209], v[194:195]
    v_lshlrev_b32 v196, 16, v74
    v_and_b32 v197, s61, v74
    v_pk_add_f32 v[208:209], v[208:209], v[196:197]
    v_lshlrev_b32 v198, 16, v75
    v_and_b32 v199, s61, v75
    v_pk_add_f32 v[208:209], v[208:209], v[198:199]
    s_waitcnt vmcnt(0)
    v_lshlrev_b32 v200, 16, v76
    v_and_b32 v201, s61, v76
    v_pk_add_f32 v[208:209], v[208:209], v[200:201]
    v_lshlrev_b32 v202, 16, v77
    v_and_b32 v203, s61, v77
    v_pk_add_f32 v[208:209], v[208:209], v[202:203]
    v_lshlrev_b32 v204, 16, v78
    v_and_b32 v205, s61, v78
    v_pk_add_f32 v[208:209], v[208:209], v[204:205]
    v_lshlrev_b32 v206, 16, v79
    v_and_b32 v207, s61, v79
    v_pk_add_f32 v[208:209], v[208:209], v[206:207]
    v_add_f32 v208, v208, v209
    v_mov_b32 v209, v208
    s_nop 1
    v_permlane16_swap_b32 v208, v209
    v_add_f32 v208, v208, v209
    v_mov_b32 v209, v208
    s_nop 1
    v_permlane32_swap_b32 v208, v209
    v_add_f32 v208, v208, v209
    v_mul_f32 v208, 0x3b000000, v208
    v_mov_b32 v210, v208
    v_mov_b64 v[208:209], 0
    v_pk_add_f32 v[212:213], v[80:81], v[210:211] op_sel_hi:[1,0] neg_lo:[0,1] neg_hi:[0,1]
    v_pk_fma_f32 v[208:209], v[212:213], v[212:213], v[208:209]
    v_pk_add_f32 v[212:213], v[82:83], v[210:211] op_sel_hi:[1,0] neg_lo:[0,1] neg_hi:[0,1]
    v_pk_fma_f32 v[208:209], v[212:213], v[212:213], v[208:209]
    v_pk_add_f32 v[212:213], v[84:85], v[210:211] op_sel_hi:[1,0] neg_lo:[0,1] neg_hi:[0,1]
    v_pk_fma_f32 v[208:209], v[212:213], v[212:213], v[208:209]
    v_pk_add_f32 v[212:213], v[86:87], v[210:211] op_sel_hi:[1,0] neg_lo:[0,1] neg_hi:[0,1]
    v_pk_fma_f32 v[208:209], v[212:213], v[212:213], v[208:209]
    v_pk_add_f32 v[212:213], v[88:89], v[210:211] op_sel_hi:[1,0] neg_lo:[0,1] neg_hi:[0,1]
    v_pk_fma_f32 v[208:209], v[212:213], v[212:213], v[208:209]
    v_pk_add_f32 v[212:213], v[90:91], v[210:211] op_sel_hi:[1,0] neg_lo:[0,1] neg_hi:[0,1]
    v_pk_fma_f32 v[208:209], v[212:213], v[212:213], v[208:209]
    v_pk_add_f32 v[212:213], v[92:93], v[210:211] op_sel_hi:[1,0] neg_lo:[0,1] neg_hi:[0,1]
    v_pk_fma_f32 v[208:209], v[212:213], v[212:213], v[208:209]
    v_pk_add_f32 v[212:213], v[94:95], v[210:211] op_sel_hi:[1,0] neg_lo:[0,1] neg_hi:[0,1]
    v_pk_fma_f32 v[208:209], v[212:213], v[212:213], v[208:209]
    v_pk_add_f32 v[212:213], v[96:97], v[210:211] op_sel_hi:[1,0] neg_lo:[0,1] neg_hi:[0,1]
    v_pk_fma_f32 v[208:209], v[212:213], v[212:213], v[208:209]
    v_pk_add_f32 v[212:213], v[98:99], v[210:211] op_sel_hi:[1,0] neg_lo:[0,1] neg_hi:[0,1]
    v_pk_fma_f32 v[208:209], v[212:213], v[212:213], v[208:209]
    v_pk_add_f32 v[212:213], v[100:101], v[210:211] op_sel_hi:[1,0] neg_lo:[0,1] neg_hi:[0,1]
    v_pk_fma_f32 v[208:209], v[212:213], v[212:213], v[208:209]
    v_pk_add_f32 v[212:213], v[102:103], v[210:211] op_sel_hi:[1,0] neg_lo:[0,1] neg_hi:[0,1]
    v_pk_fma_f32 v[208:209], v[212:213], v[212:213], v[208:209]
    v_pk_add_f32 v[212:213], v[104:105], v[210:211] op_sel_hi:[1,0] neg_lo:[0,1] neg_hi:[0,1]
    v_pk_fma_f32 v[208:209], v[212:213], v[212:213], v[208:209]
    v_pk_add_f32 v[212:213], v[106:107], v[210:211] op_sel_hi:[1,0] neg_lo:[0,1] neg_hi:[0,1]
    v_pk_fma_f32 v[208:209], v[212:213], v[212:213], v[208:209]
    v_pk_add_f32 v[212:213], v[108:109], v[210:211] op_sel_hi:[1,0] neg_lo:[0,1] neg_hi:[0,1]
    v_pk_fma_f32 v[208:209], v[212:213], v[212:213], v[208:209]
    v_pk_add_f32 v[212:213], v[110:111], v[210:211] op_sel_hi:[1,0] neg_lo:[0,1] neg_hi:[0,1]
    v_pk_fma_f32 v[208:209], v[212:213], v[212:213], v[208:209]
    v_pk_add_f32 v[212:213], v[112:113], v[210:211] op_sel_hi:[1,0] neg_lo:[0,1] neg_hi:[0,1]
    v_pk_fma_f32 v[208:209], v[212:213], v[212:213], v[208:209]
    v_pk_add_f32 v[212:213], v[114:115], v[210:211] op_sel_hi:[1,0] neg_lo:[0,1] neg_hi:[0,1]
    v_pk_fma_f32 v[208:209], v[212:213], v[212:213], v[208:209]
    v_pk_add_f32 v[212:213], v[116:117], v[210:211] op_sel_hi:[1,0] neg_lo:[0,1] neg_hi:[0,1]
    v_pk_fma_f32 v[208:209], v[212:213], v[212:213], v[208:209]
    v_pk_add_f32 v[212:213], v[118:119], v[210:211] op_sel_hi:[1,0] neg_lo:[0,1] neg_hi:[0,1]
    v_pk_fma_f32 v[208:209], v[212:213], v[212:213], v[208:209]
    v_pk_add_f32 v[212:213], v[120:121], v[210:211] op_sel_hi:[1,0] neg_lo:[0,1] neg_hi:[0,1]
    v_pk_fma_f32 v[208:209], v[212:213], v[212:213], v[208:209]
    v_pk_add_f32 v[212:213], v[122:123], v[210:211] op_sel_hi:[1,0] neg_lo:[0,1] neg_hi:[0,1]
    v_pk_fma_f32 v[208:209], v[212:213], v[212:213], v[208:209]
    v_pk_add_f32 v[212:213], v[124:125], v[210:211] op_sel_hi:[1,0] neg_lo:[0,1] neg_hi:[0,1]
    v_pk_fma_f32 v[208:209], v[212:213], v[212:213], v[208:209]
    v_pk_add_f32 v[212:213], v[126:127], v[210:211] op_sel_hi:[1,0] neg_lo:[0,1] neg_hi:[0,1]
    v_pk_fma_f32 v[208:209], v[212:213], v[212:213], v[208:209]
    v_pk_add_f32 v[212:213], v[128:129], v[210:211] op_sel_hi:[1,0] neg_lo:[0,1] neg_hi:[0,1]
    v_pk_fma_f32 v[208:209], v[212:213], v[212:213], v[208:209]
    v_pk_add_f32 v[212:213], v[130:131], v[210:211] op_sel_hi:[1,0] neg_lo:[0,1] neg_hi:[0,1]
    v_pk_fma_f32 v[208:209], v[212:213], v[212:213], v[208:209]
    v_pk_add_f32 v[212:213], v[132:133], v[210:211] op_sel_hi:[1,0] neg_lo:[0,1] neg_hi:[0,1]
    v_pk_fma_f32 v[208:209], v[212:213], v[212:213], v[208:209]
    v_pk_add_f32 v[212:213], v[134:135], v[210:211] op_sel_hi:[1,0] neg_lo:[0,1] neg_hi:[0,1]
    v_pk_fma_f32 v[208:209], v[212:213], v[212:213], v[208:209]
    v_pk_add_f32 v[212:213], v[136:137], v[210:211] op_sel_hi:[1,0] neg_lo:[0,1] neg_hi:[0,1]
    v_pk_fma_f32 v[208:209], v[212:213], v[212:213], v[208:209]
    v_pk_add_f32 v[212:213], v[138:139], v[210:211] op_sel_hi:[1,0] neg_lo:[0,1] neg_hi:[0,1]
    v_pk_fma_f32 v[208:209], v[212:213], v[212:213], v[208:209]
    v_pk_add_f32 v[212:213], v[140:141], v[210:211] op_sel_hi:[1,0] neg_lo:[0,1] neg_hi:[0,1]
    v_pk_fma_f32 v[208:209], v[212:213], v[212:213], v[208:209]
    v_pk_add_f32 v[212:213], v[142:143], v[210:211] op_sel_hi:[1,0] neg_lo:[0,1] neg_hi:[0,1]
    v_pk_fma_f32 v[208:209], v[212:213], v[212:213], v[208:209]
    v_pk_add_f32 v[212:213], v[144:145], v[210:211] op_sel_hi:[1,0] neg_lo:[0,1] neg_hi:[0,1]
    v_pk_fma_f32 v[208:209], v[212:213], v[212:213], v[208:209]
    v_pk_add_f32 v[212:213], v[146:147], v[210:211] op_sel_hi:[1,0] neg_lo:[0,1] neg_hi:[0,1]
    v_pk_fma_f32 v[208:209], v[212:213], v[212:213], v[208:209]
    v_pk_add_f32 v[212:213], v[148:149], v[210:211] op_sel_hi:[1,0] neg_lo:[0,1] neg_hi:[0,1]
    v_pk_fma_f32 v[208:209], v[212:213], v[212:213], v[208:209]
    v_pk_add_f32 v[212:213], v[150:151], v[210:211] op_sel_hi:[1,0] neg_lo:[0,1] neg_hi:[0,1]
    v_pk_fma_f32 v[208:209], v[212:213], v[212:213], v[208:209]
    v_pk_add_f32 v[212:213], v[152:153], v[210:211] op_sel_hi:[1,0] neg_lo:[0,1] neg_hi:[0,1]
    v_pk_fma_f32 v[208:209], v[212:213], v[212:213], v[208:209]
    v_pk_add_f32 v[212:213], v[154:155], v[210:211] op_sel_hi:[1,0] neg_lo:[0,1] neg_hi:[0,1]
    v_pk_fma_f32 v[208:209], v[212:213], v[212:213], v[208:209]
    v_pk_add_f32 v[212:213], v[156:157], v[210:211] op_sel_hi:[1,0] neg_lo:[0,1] neg_hi:[0,1]
    v_pk_fma_f32 v[208:209], v[212:213], v[212:213], v[208:209]
    v_pk_add_f32 v[212:213], v[158:159], v[210:211] op_sel_hi:[1,0] neg_lo:[0,1] neg_hi:[0,1]
    v_pk_fma_f32 v[208:209], v[212:213], v[212:213], v[208:209]
    v_pk_add_f32 v[212:213], v[160:161], v[210:211] op_sel_hi:[1,0] neg_lo:[0,1] neg_hi:[0,1]
    v_pk_fma_f32 v[208:209], v[212:213], v[212:213], v[208:209]
    v_pk_add_f32 v[212:213], v[162:163], v[210:211] op_sel_hi:[1,0] neg_lo:[0,1] neg_hi:[0,1]
    v_pk_fma_f32 v[208:209], v[212:213], v[212:213], v[208:209]
    v_pk_add_f32 v[212:213], v[164:165], v[210:211] op_sel_hi:[1,0] neg_lo:[0,1] neg_hi:[0,1]
    v_pk_fma_f32 v[208:209], v[212:213], v[212:213], v[208:209]
    v_pk_add_f32 v[212:213], v[166:167], v[210:211] op_sel_hi:[1,0] neg_lo:[0,1] neg_hi:[0,1]
    v_pk_fma_f32 v[208:209], v[212:213], v[212:213], v[208:209]
    v_pk_add_f32 v[212:213], v[168:169], v[210:211] op_sel_hi:[1,0] neg_lo:[0,1] neg_hi:[0,1]
    v_pk_fma_f32 v[208:209], v[212:213], v[212:213], v[208:209]
    v_pk_add_f32 v[212:213], v[170:171], v[210:211] op_sel_hi:[1,0] neg_lo:[0,1] neg_hi:[0,1]
    v_pk_fma_f32 v[208:209], v[212:213], v[212:213], v[208:209]
    v_pk_add_f32 v[212:213], v[172:173], v[210:211] op_sel_hi:[1,0] neg_lo:[0,1] neg_hi:[0,1]
    v_pk_fma_f32 v[208:209], v[212:213], v[212:213], v[208:209]
    v_pk_add_f32 v[212:213], v[174:175], v[210:211] op_sel_hi:[1,0] neg_lo:[0,1] neg_hi:[0,1]
    v_pk_fma_f32 v[208:209], v[212:213], v[212:213], v[208:209]
    v_pk_add_f32 v[212:213], v[176:177], v[210:211] op_sel_hi:[1,0] neg_lo:[0,1] neg_hi:[0,1]
    v_pk_fma_f32 v[208:209], v[212:213], v[212:213], v[208:209]
    v_pk_add_f32 v[212:213], v[178:179], v[210:211] op_sel_hi:[1,0] neg_lo:[0,1] neg_hi:[0,1]
    v_pk_fma_f32 v[208:209], v[212:213], v[212:213], v[208:209]
    v_pk_add_f32 v[212:213], v[180:181], v[210:211] op_sel_hi:[1,0] neg_lo:[0,1] neg_hi:[0,1]
    v_pk_fma_f32 v[208:209], v[212:213], v[212:213], v[208:209]
    v_pk_add_f32 v[212:213], v[182:183], v[210:211] op_sel_hi:[1,0] neg_lo:[0,1] neg_hi:[0,1]
    v_pk_fma_f32 v[208:209], v[212:213], v[212:213], v[208:209]
    v_pk_add_f32 v[212:213], v[184:185], v[210:211] op_sel_hi:[1,0] neg_lo:[0,1] neg_hi:[0,1]
    v_pk_fma_f32 v[208:209], v[212:213], v[212:213], v[208:209]
    v_pk_add_f32 v[212:213], v[186:187], v[210:211] op_sel_hi:[1,0] neg_lo:[0,1] neg_hi:[0,1]
    v_pk_fma_f32 v[208:209], v[212:213], v[212:213], v[208:209]
    v_pk_add_f32 v[212:213], v[188:189], v[210:211] op_sel_hi:[1,0] neg_lo:[0,1] neg_hi:[0,1]
    v_pk_fma_f32 v[208:209], v[212:213], v[212:213], v[208:209]
    v_pk_add_f32 v[212:213], v[190:191], v[210:211] op_sel_hi:[1,0] neg_lo:[0,1] neg_hi:[0,1]
    v_pk_fma_f32 v[208:209], v[212:213], v[212:213], v[208:209]
    v_pk_add_f32 v[212:213], v[192:193], v[210:211] op_sel_hi:[1,0] neg_lo:[0,1] neg_hi:[0,1]
    v_pk_fma_f32 v[208:209], v[212:213], v[212:213], v[208:209]
    v_pk_add_f32 v[212:213], v[194:195], v[210:211] op_sel_hi:[1,0] neg_lo:[0,1] neg_hi:[0,1]
    v_pk_fma_f32 v[208:209], v[212:213], v[212:213], v[208:209]
    v_pk_add_f32 v[212:213], v[196:197], v[210:211] op_sel_hi:[1,0] neg_lo:[0,1] neg_hi:[0,1]
    v_pk_fma_f32 v[208:209], v[212:213], v[212:213], v[208:209]
    v_pk_add_f32 v[212:213], v[198:199], v[210:211] op_sel_hi:[1,0] neg_lo:[0,1] neg_hi:[0,1]
    v_pk_fma_f32 v[208:209], v[212:213], v[212:213], v[208:209]
    v_pk_add_f32 v[212:213], v[200:201], v[210:211] op_sel_hi:[1,0] neg_lo:[0,1] neg_hi:[0,1]
    v_pk_fma_f32 v[208:209], v[212:213], v[212:213], v[208:209]
    v_pk_add_f32 v[212:213], v[202:203], v[210:211] op_sel_hi:[1,0] neg_lo:[0,1] neg_hi:[0,1]
    v_pk_fma_f32 v[208:209], v[212:213], v[212:213], v[208:209]
    v_pk_add_f32 v[212:213], v[204:205], v[210:211] op_sel_hi:[1,0] neg_lo:[0,1] neg_hi:[0,1]
    v_pk_fma_f32 v[208:209], v[212:213], v[212:213], v[208:209]
    v_pk_add_f32 v[212:213], v[206:207], v[210:211] op_sel_hi:[1,0] neg_lo:[0,1] neg_hi:[0,1]
    v_pk_fma_f32 v[208:209], v[212:213], v[212:213], v[208:209]
    v_add_f32 v208, v208, v209
    v_mov_b32 v209, v208
    s_nop 1
    v_permlane16_swap_b32 v208, v209
    v_add_f32 v208, v208, v209
    v_mov_b32 v209, v208
    s_nop 1
    v_permlane32_swap_b32 v208, v209
    v_add_f32 v208, v208, v209
    v_mul_f32 v208, 0x3b000000, v208
    v_cvt_pk_bf16_f32 v208, v208, v208
    v_lshlrev_b32 v208, 16, v208
    v_add_f32 v208, 0x3727c5ac, v208
    v_cvt_pk_bf16_f32 v208, v208, v208
    v_lshlrev_b32 v208, 16, v208
    v_sqrt_f32 v208, v208
    s_nop 0
    v_cvt_pk_bf16_f32 v208, v208, v208
    v_lshlrev_b32 v208, 16, v208
    v_rcp_f32 v208, v208
    v_cvt_pk_bf16_f32 v210, v210, v210
    v_lshlrev_b32 v210, 16, v210
    s_lshl_b32 s56, s60, 14
    s_add_u32 s56, s56, 0x200000
    v_pk_add_f32 v[80:81], v[80:81], v[210:211] op_sel_hi:[1,0] neg_lo:[0,1] neg_hi:[0,1]
    v_cvt_pk_bf16_f32 v16, v80, v81
    v_lshlrev_b32 v80, 16, v16
    v_and_b32 v81, s61, v16
    v_pk_mul_f32 v[80:81], v[80:81], v[208:209] op_sel_hi:[1,0]
    v_cvt_pk_bf16_f32 v16, v80, v81
    v_pk_add_f32 v[82:83], v[82:83], v[210:211] op_sel_hi:[1,0] neg_lo:[0,1] neg_hi:[0,1]
    v_cvt_pk_bf16_f32 v17, v82, v83
    v_lshlrev_b32 v82, 16, v17
    v_and_b32 v83, s61, v17
    v_pk_mul_f32 v[82:83], v[82:83], v[208:209] op_sel_hi:[1,0]
    v_cvt_pk_bf16_f32 v17, v82, v83
    v_pk_add_f32 v[84:85], v[84:85], v[210:211] op_sel_hi:[1,0] neg_lo:[0,1] neg_hi:[0,1]
    v_cvt_pk_bf16_f32 v18, v84, v85
    v_lshlrev_b32 v84, 16, v18
    v_and_b32 v85, s61, v18
    v_pk_mul_f32 v[84:85], v[84:85], v[208:209] op_sel_hi:[1,0]
    v_cvt_pk_bf16_f32 v18, v84, v85
    v_pk_add_f32 v[86:87], v[86:87], v[210:211] op_sel_hi:[1,0] neg_lo:[0,1] neg_hi:[0,1]
    v_cvt_pk_bf16_f32 v19, v86, v87
    v_lshlrev_b32 v86, 16, v19
    v_and_b32 v87, s61, v19
    v_pk_mul_f32 v[86:87], v[86:87], v[208:209] op_sel_hi:[1,0]
    v_cvt_pk_bf16_f32 v19, v86, v87
    buffer_store_dwordx4 v[16:19], v1, s[4:7], s56 offen offset:0 sc1
    v_pk_add_f32 v[88:89], v[88:89], v[210:211] op_sel_hi:[1,0] neg_lo:[0,1] neg_hi:[0,1]
    v_cvt_pk_bf16_f32 v20, v88, v89
    v_lshlrev_b32 v88, 16, v20
    v_and_b32 v89, s61, v20
    v_pk_mul_f32 v[88:89], v[88:89], v[208:209] op_sel_hi:[1,0]
    v_cvt_pk_bf16_f32 v20, v88, v89
    v_pk_add_f32 v[90:91], v[90:91], v[210:211] op_sel_hi:[1,0] neg_lo:[0,1] neg_hi:[0,1]
    v_cvt_pk_bf16_f32 v21, v90, v91
    v_lshlrev_b32 v90, 16, v21
    v_and_b32 v91, s61, v21
    v_pk_mul_f32 v[90:91], v[90:91], v[208:209] op_sel_hi:[1,0]
    v_cvt_pk_bf16_f32 v21, v90, v91
    v_pk_add_f32 v[92:93], v[92:93], v[210:211] op_sel_hi:[1,0] neg_lo:[0,1] neg_hi:[0,1]
    v_cvt_pk_bf16_f32 v22, v92, v93
    v_lshlrev_b32 v92, 16, v22
    v_and_b32 v93, s61, v22
    v_pk_mul_f32 v[92:93], v[92:93], v[208:209] op_sel_hi:[1,0]
    v_cvt_pk_bf16_f32 v22, v92, v93
    v_pk_add_f32 v[94:95], v[94:95], v[210:211] op_sel_hi:[1,0] neg_lo:[0,1] neg_hi:[0,1]
    v_cvt_pk_bf16_f32 v23, v94, v95
    v_lshlrev_b32 v94, 16, v23
    v_and_b32 v95, s61, v23
    v_pk_mul_f32 v[94:95], v[94:95], v[208:209] op_sel_hi:[1,0]
    v_cvt_pk_bf16_f32 v23, v94, v95
    buffer_store_dwordx4 v[20:23], v1, s[4:7], s56 offen offset:1024 sc1
    v_pk_add_f32 v[96:97], v[96:97], v[210:211] op_sel_hi:[1,0] neg_lo:[0,1] neg_hi:[0,1]
    v_cvt_pk_bf16_f32 v24, v96, v97
    v_lshlrev_b32 v96, 16, v24
    v_and_b32 v97, s61, v24
    v_pk_mul_f32 v[96:97], v[96:97], v[208:209] op_sel_hi:[1,0]
    v_cvt_pk_bf16_f32 v24, v96, v97
    v_pk_add_f32 v[98:99], v[98:99], v[210:211] op_sel_hi:[1,0] neg_lo:[0,1] neg_hi:[0,1]
    v_cvt_pk_bf16_f32 v25, v98, v99
    v_lshlrev_b32 v98, 16, v25
    v_and_b32 v99, s61, v25
    v_pk_mul_f32 v[98:99], v[98:99], v[208:209] op_sel_hi:[1,0]
    v_cvt_pk_bf16_f32 v25, v98, v99
    v_pk_add_f32 v[100:101], v[100:101], v[210:211] op_sel_hi:[1,0] neg_lo:[0,1] neg_hi:[0,1]
    v_cvt_pk_bf16_f32 v26, v100, v101
    v_lshlrev_b32 v100, 16, v26
    v_and_b32 v101, s61, v26
    v_pk_mul_f32 v[100:101], v[100:101], v[208:209] op_sel_hi:[1,0]
    v_cvt_pk_bf16_f32 v26, v100, v101
    v_pk_add_f32 v[102:103], v[102:103], v[210:211] op_sel_hi:[1,0] neg_lo:[0,1] neg_hi:[0,1]
    v_cvt_pk_bf16_f32 v27, v102, v103
    v_lshlrev_b32 v102, 16, v27
    v_and_b32 v103, s61, v27
    v_pk_mul_f32 v[102:103], v[102:103], v[208:209] op_sel_hi:[1,0]
    v_cvt_pk_bf16_f32 v27, v102, v103
    buffer_store_dwordx4 v[24:27], v1, s[4:7], s56 offen offset:2048 sc1
    v_pk_add_f32 v[104:105], v[104:105], v[210:211] op_sel_hi:[1,0] neg_lo:[0,1] neg_hi:[0,1]
    v_cvt_pk_bf16_f32 v28, v104, v105
    v_lshlrev_b32 v104, 16, v28
    v_and_b32 v105, s61, v28
    v_pk_mul_f32 v[104:105], v[104:105], v[208:209] op_sel_hi:[1,0]
    v_cvt_pk_bf16_f32 v28, v104, v105
    v_pk_add_f32 v[106:107], v[106:107], v[210:211] op_sel_hi:[1,0] neg_lo:[0,1] neg_hi:[0,1]
    v_cvt_pk_bf16_f32 v29, v106, v107
    v_lshlrev_b32 v106, 16, v29
    v_and_b32 v107, s61, v29
    v_pk_mul_f32 v[106:107], v[106:107], v[208:209] op_sel_hi:[1,0]
    v_cvt_pk_bf16_f32 v29, v106, v107
    v_pk_add_f32 v[108:109], v[108:109], v[210:211] op_sel_hi:[1,0] neg_lo:[0,1] neg_hi:[0,1]
    v_cvt_pk_bf16_f32 v30, v108, v109
    v_lshlrev_b32 v108, 16, v30
    v_and_b32 v109, s61, v30
    v_pk_mul_f32 v[108:109], v[108:109], v[208:209] op_sel_hi:[1,0]
    v_cvt_pk_bf16_f32 v30, v108, v109
    v_pk_add_f32 v[110:111], v[110:111], v[210:211] op_sel_hi:[1,0] neg_lo:[0,1] neg_hi:[0,1]
    v_cvt_pk_bf16_f32 v31, v110, v111
    v_lshlrev_b32 v110, 16, v31
    v_and_b32 v111, s61, v31
    v_pk_mul_f32 v[110:111], v[110:111], v[208:209] op_sel_hi:[1,0]
    v_cvt_pk_bf16_f32 v31, v110, v111
    buffer_store_dwordx4 v[28:31], v1, s[4:7], s56 offen offset:3072 sc1
    s_add_u32 s56, s56, 4096
    v_pk_add_f32 v[112:113], v[112:113], v[210:211] op_sel_hi:[1,0] neg_lo:[0,1] neg_hi:[0,1]
    v_cvt_pk_bf16_f32 v32, v112, v113
    v_lshlrev_b32 v112, 16, v32
    v_and_b32 v113, s61, v32
    v_pk_mul_f32 v[112:113], v[112:113], v[208:209] op_sel_hi:[1,0]
    v_cvt_pk_bf16_f32 v32, v112, v113
    v_pk_add_f32 v[114:115], v[114:115], v[210:211] op_sel_hi:[1,0] neg_lo:[0,1] neg_hi:[0,1]
    v_cvt_pk_bf16_f32 v33, v114, v115
    v_lshlrev_b32 v114, 16, v33
    v_and_b32 v115, s61, v33
    v_pk_mul_f32 v[114:115], v[114:115], v[208:209] op_sel_hi:[1,0]
    v_cvt_pk_bf16_f32 v33, v114, v115
    v_pk_add_f32 v[116:117], v[116:117], v[210:211] op_sel_hi:[1,0] neg_lo:[0,1] neg_hi:[0,1]
    v_cvt_pk_bf16_f32 v34, v116, v117
    v_lshlrev_b32 v116, 16, v34
    v_and_b32 v117, s61, v34
    v_pk_mul_f32 v[116:117], v[116:117], v[208:209] op_sel_hi:[1,0]
    v_cvt_pk_bf16_f32 v34, v116, v117
    v_pk_add_f32 v[118:119], v[118:119], v[210:211] op_sel_hi:[1,0] neg_lo:[0,1] neg_hi:[0,1]
    v_cvt_pk_bf16_f32 v35, v118, v119
    v_lshlrev_b32 v118, 16, v35
    v_and_b32 v119, s61, v35
    v_pk_mul_f32 v[118:119], v[118:119], v[208:209] op_sel_hi:[1,0]
    v_cvt_pk_bf16_f32 v35, v118, v119
    buffer_store_dwordx4 v[32:35], v1, s[4:7], s56 offen offset:0 sc1
    v_pk_add_f32 v[120:121], v[120:121], v[210:211] op_sel_hi:[1,0] neg_lo:[0,1] neg_hi:[0,1]
    v_cvt_pk_bf16_f32 v36, v120, v121
    v_lshlrev_b32 v120, 16, v36
    v_and_b32 v121, s61, v36
    v_pk_mul_f32 v[120:121], v[120:121], v[208:209] op_sel_hi:[1,0]
    v_cvt_pk_bf16_f32 v36, v120, v121
    v_pk_add_f32 v[122:123], v[122:123], v[210:211] op_sel_hi:[1,0] neg_lo:[0,1] neg_hi:[0,1]
    v_cvt_pk_bf16_f32 v37, v122, v123
    v_lshlrev_b32 v122, 16, v37
    v_and_b32 v123, s61, v37
    v_pk_mul_f32 v[122:123], v[122:123], v[208:209] op_sel_hi:[1,0]
    v_cvt_pk_bf16_f32 v37, v122, v123
    v_pk_add_f32 v[124:125], v[124:125], v[210:211] op_sel_hi:[1,0] neg_lo:[0,1] neg_hi:[0,1]
    v_cvt_pk_bf16_f32 v38, v124, v125
    v_lshlrev_b32 v124, 16, v38
    v_and_b32 v125, s61, v38
    v_pk_mul_f32 v[124:125], v[124:125], v[208:209] op_sel_hi:[1,0]
    v_cvt_pk_bf16_f32 v38, v124, v125
    v_pk_add_f32 v[126:127], v[126:127], v[210:211] op_sel_hi:[1,0] neg_lo:[0,1] neg_hi:[0,1]
    v_cvt_pk_bf16_f32 v39, v126, v127
    v_lshlrev_b32 v126, 16, v39
    v_and_b32 v127, s61, v39
    v_pk_mul_f32 v[126:127], v[126:127], v[208:209] op_sel_hi:[1,0]
    v_cvt_pk_bf16_f32 v39, v126, v127
    buffer_store_dwordx4 v[36:39], v1, s[4:7], s56 offen offset:1024 sc1
    v_pk_add_f32 v[128:129], v[128:129], v[210:211] op_sel_hi:[1,0] neg_lo:[0,1] neg_hi:[0,1]
    v_cvt_pk_bf16_f32 v40, v128, v129
    v_lshlrev_b32 v128, 16, v40
    v_and_b32 v129, s61, v40
    v_pk_mul_f32 v[128:129], v[128:129], v[208:209] op_sel_hi:[1,0]
    v_cvt_pk_bf16_f32 v40, v128, v129
    v_pk_add_f32 v[130:131], v[130:131], v[210:211] op_sel_hi:[1,0] neg_lo:[0,1] neg_hi:[0,1]
    v_cvt_pk_bf16_f32 v41, v130, v131
    v_lshlrev_b32 v130, 16, v41
    v_and_b32 v131, s61, v41
    v_pk_mul_f32 v[130:131], v[130:131], v[208:209] op_sel_hi:[1,0]
    v_cvt_pk_bf16_f32 v41, v130, v131
    v_pk_add_f32 v[132:133], v[132:133], v[210:211] op_sel_hi:[1,0] neg_lo:[0,1] neg_hi:[0,1]
    v_cvt_pk_bf16_f32 v42, v132, v133
    v_lshlrev_b32 v132, 16, v42
    v_and_b32 v133, s61, v42
    v_pk_mul_f32 v[132:133], v[132:133], v[208:209] op_sel_hi:[1,0]
    v_cvt_pk_bf16_f32 v42, v132, v133
    v_pk_add_f32 v[134:135], v[134:135], v[210:211] op_sel_hi:[1,0] neg_lo:[0,1] neg_hi:[0,1]
    v_cvt_pk_bf16_f32 v43, v134, v135
    v_lshlrev_b32 v134, 16, v43
    v_and_b32 v135, s61, v43
    v_pk_mul_f32 v[134:135], v[134:135], v[208:209] op_sel_hi:[1,0]
    v_cvt_pk_bf16_f32 v43, v134, v135
    buffer_store_dwordx4 v[40:43], v1, s[4:7], s56 offen offset:2048 sc1
    v_pk_add_f32 v[136:137], v[136:137], v[210:211] op_sel_hi:[1,0] neg_lo:[0,1] neg_hi:[0,1]
    v_cvt_pk_bf16_f32 v44, v136, v137
    v_lshlrev_b32 v136, 16, v44
    v_and_b32 v137, s61, v44
    v_pk_mul_f32 v[136:137], v[136:137], v[208:209] op_sel_hi:[1,0]
    v_cvt_pk_bf16_f32 v44, v136, v137
    v_pk_add_f32 v[138:139], v[138:139], v[210:211] op_sel_hi:[1,0] neg_lo:[0,1] neg_hi:[0,1]
    v_cvt_pk_bf16_f32 v45, v138, v139
    v_lshlrev_b32 v138, 16, v45
    v_and_b32 v139, s61, v45
    v_pk_mul_f32 v[138:139], v[138:139], v[208:209] op_sel_hi:[1,0]
    v_cvt_pk_bf16_f32 v45, v138, v139
    v_pk_add_f32 v[140:141], v[140:141], v[210:211] op_sel_hi:[1,0] neg_lo:[0,1] neg_hi:[0,1]
    v_cvt_pk_bf16_f32 v46, v140, v141
    v_lshlrev_b32 v140, 16, v46
    v_and_b32 v141, s61, v46
    v_pk_mul_f32 v[140:141], v[140:141], v[208:209] op_sel_hi:[1,0]
    v_cvt_pk_bf16_f32 v46, v140, v141
    v_pk_add_f32 v[142:143], v[142:143], v[210:211] op_sel_hi:[1,0] neg_lo:[0,1] neg_hi:[0,1]
    v_cvt_pk_bf16_f32 v47, v142, v143
    v_lshlrev_b32 v142, 16, v47
    v_and_b32 v143, s61, v47
    v_pk_mul_f32 v[142:143], v[142:143], v[208:209] op_sel_hi:[1,0]
    v_cvt_pk_bf16_f32 v47, v142, v143
    buffer_store_dwordx4 v[44:47], v1, s[4:7], s56 offen offset:3072 sc1
    s_add_u32 s56, s56, 4096
    v_pk_add_f32 v[144:145], v[144:145], v[210:211] op_sel_hi:[1,0] neg_lo:[0,1] neg_hi:[0,1]
    v_cvt_pk_bf16_f32 v48, v144, v145
    v_lshlrev_b32 v144, 16, v48
    v_and_b32 v145, s61, v48
    v_pk_mul_f32 v[144:145], v[144:145], v[208:209] op_sel_hi:[1,0]
    v_cvt_pk_bf16_f32 v48, v144, v145
    v_pk_add_f32 v[146:147], v[146:147], v[210:211] op_sel_hi:[1,0] neg_lo:[0,1] neg_hi:[0,1]
    v_cvt_pk_bf16_f32 v49, v146, v147
    v_lshlrev_b32 v146, 16, v49
    v_and_b32 v147, s61, v49
    v_pk_mul_f32 v[146:147], v[146:147], v[208:209] op_sel_hi:[1,0]
    v_cvt_pk_bf16_f32 v49, v146, v147
    v_pk_add_f32 v[148:149], v[148:149], v[210:211] op_sel_hi:[1,0] neg_lo:[0,1] neg_hi:[0,1]
    v_cvt_pk_bf16_f32 v50, v148, v149
    v_lshlrev_b32 v148, 16, v50
    v_and_b32 v149, s61, v50
    v_pk_mul_f32 v[148:149], v[148:149], v[208:209] op_sel_hi:[1,0]
    v_cvt_pk_bf16_f32 v50, v148, v149
    v_pk_add_f32 v[150:151], v[150:151], v[210:211] op_sel_hi:[1,0] neg_lo:[0,1] neg_hi:[0,1]
    v_cvt_pk_bf16_f32 v51, v150, v151
    v_lshlrev_b32 v150, 16, v51
    v_and_b32 v151, s61, v51
    v_pk_mul_f32 v[150:151], v[150:151], v[208:209] op_sel_hi:[1,0]
    v_cvt_pk_bf16_f32 v51, v150, v151
    buffer_store_dwordx4 v[48:51], v1, s[4:7], s56 offen offset:0 sc1
    v_pk_add_f32 v[152:153], v[152:153], v[210:211] op_sel_hi:[1,0] neg_lo:[0,1] neg_hi:[0,1]
    v_cvt_pk_bf16_f32 v52, v152, v153
    v_lshlrev_b32 v152, 16, v52
    v_and_b32 v153, s61, v52
    v_pk_mul_f32 v[152:153], v[152:153], v[208:209] op_sel_hi:[1,0]
    v_cvt_pk_bf16_f32 v52, v152, v153
    v_pk_add_f32 v[154:155], v[154:155], v[210:211] op_sel_hi:[1,0] neg_lo:[0,1] neg_hi:[0,1]
    v_cvt_pk_bf16_f32 v53, v154, v155
    v_lshlrev_b32 v154, 16, v53
    v_and_b32 v155, s61, v53
    v_pk_mul_f32 v[154:155], v[154:155], v[208:209] op_sel_hi:[1,0]
    v_cvt_pk_bf16_f32 v53, v154, v155
    v_pk_add_f32 v[156:157], v[156:157], v[210:211] op_sel_hi:[1,0] neg_lo:[0,1] neg_hi:[0,1]
    v_cvt_pk_bf16_f32 v54, v156, v157
    v_lshlrev_b32 v156, 16, v54
    v_and_b32 v157, s61, v54
    v_pk_mul_f32 v[156:157], v[156:157], v[208:209] op_sel_hi:[1,0]
    v_cvt_pk_bf16_f32 v54, v156, v157
    v_pk_add_f32 v[158:159], v[158:159], v[210:211] op_sel_hi:[1,0] neg_lo:[0,1] neg_hi:[0,1]
    v_cvt_pk_bf16_f32 v55, v158, v159
    v_lshlrev_b32 v158, 16, v55
    v_and_b32 v159, s61, v55
    v_pk_mul_f32 v[158:159], v[158:159], v[208:209] op_sel_hi:[1,0]
    v_cvt_pk_bf16_f32 v55, v158, v159
    buffer_store_dwordx4 v[52:55], v1, s[4:7], s56 offen offset:1024 sc1
    v_pk_add_f32 v[160:161], v[160:161], v[210:211] op_sel_hi:[1,0] neg_lo:[0,1] neg_hi:[0,1]
    v_cvt_pk_bf16_f32 v56, v160, v161
    v_lshlrev_b32 v160, 16, v56
    v_and_b32 v161, s61, v56
    v_pk_mul_f32 v[160:161], v[160:161], v[208:209] op_sel_hi:[1,0]
    v_cvt_pk_bf16_f32 v56, v160, v161
    v_pk_add_f32 v[162:163], v[162:163], v[210:211] op_sel_hi:[1,0] neg_lo:[0,1] neg_hi:[0,1]
    v_cvt_pk_bf16_f32 v57, v162, v163
    v_lshlrev_b32 v162, 16, v57
    v_and_b32 v163, s61, v57
    v_pk_mul_f32 v[162:163], v[162:163], v[208:209] op_sel_hi:[1,0]
    v_cvt_pk_bf16_f32 v57, v162, v163
    v_pk_add_f32 v[164:165], v[164:165], v[210:211] op_sel_hi:[1,0] neg_lo:[0,1] neg_hi:[0,1]
    v_cvt_pk_bf16_f32 v58, v164, v165
    v_lshlrev_b32 v164, 16, v58
    v_and_b32 v165, s61, v58
    v_pk_mul_f32 v[164:165], v[164:165], v[208:209] op_sel_hi:[1,0]
    v_cvt_pk_bf16_f32 v58, v164, v165
    v_pk_add_f32 v[166:167], v[166:167], v[210:211] op_sel_hi:[1,0] neg_lo:[0,1] neg_hi:[0,1]
    v_cvt_pk_bf16_f32 v59, v166, v167
    v_lshlrev_b32 v166, 16, v59
    v_and_b32 v167, s61, v59
    v_pk_mul_f32 v[166:167], v[166:167], v[208:209] op_sel_hi:[1,0]
    v_cvt_pk_bf16_f32 v59, v166, v167
    buffer_store_dwordx4 v[56:59], v1, s[4:7], s56 offen offset:2048 sc1
    v_pk_add_f32 v[168:169], v[168:169], v[210:211] op_sel_hi:[1,0] neg_lo:[0,1] neg_hi:[0,1]
    v_cvt_pk_bf16_f32 v60, v168, v169
    v_lshlrev_b32 v168, 16, v60
    v_and_b32 v169, s61, v60
    v_pk_mul_f32 v[168:169], v[168:169], v[208:209] op_sel_hi:[1,0]
    v_cvt_pk_bf16_f32 v60, v168, v169
    v_pk_add_f32 v[170:171], v[170:171], v[210:211] op_sel_hi:[1,0] neg_lo:[0,1] neg_hi:[0,1]
    v_cvt_pk_bf16_f32 v61, v170, v171
    v_lshlrev_b32 v170, 16, v61
    v_and_b32 v171, s61, v61
    v_pk_mul_f32 v[170:171], v[170:171], v[208:209] op_sel_hi:[1,0]
    v_cvt_pk_bf16_f32 v61, v170, v171
    v_pk_add_f32 v[172:173], v[172:173], v[210:211] op_sel_hi:[1,0] neg_lo:[0,1] neg_hi:[0,1]
    v_cvt_pk_bf16_f32 v62, v172, v173
    v_lshlrev_b32 v172, 16, v62
    v_and_b32 v173, s61, v62
    v_pk_mul_f32 v[172:173], v[172:173], v[208:209] op_sel_hi:[1,0]
    v_cvt_pk_bf16_f32 v62, v172, v173
    v_pk_add_f32 v[174:175], v[174:175], v[210:211] op_sel_hi:[1,0] neg_lo:[0,1] neg_hi:[0,1]
    v_cvt_pk_bf16_f32 v63, v174, v175
    v_lshlrev_b32 v174, 16, v63
    v_and_b32 v175, s61, v63
    v_pk_mul_f32 v[174:175], v[174:175], v[208:209] op_sel_hi:[1,0]
    v_cvt_pk_bf16_f32 v63, v174, v175
    buffer_store_dwordx4 v[60:63], v1, s[4:7], s56 offen offset:3072 sc1
    s_add_u32 s56, s56, 4096
    v_pk_add_f32 v[176:177], v[176:177], v[210:211] op_sel_hi:[1,0] neg_lo:[0,1] neg_hi:[0,1]
    v_cvt_pk_bf16_f32 v64, v176, v177
    v_lshlrev_b32 v176, 16, v64
    v_and_b32 v177, s61, v64
    v_pk_mul_f32 v[176:177], v[176:177], v[208:209] op_sel_hi:[1,0]
    v_cvt_pk_bf16_f32 v64, v176, v177
    v_pk_add_f32 v[178:179], v[178:179], v[210:211] op_sel_hi:[1,0] neg_lo:[0,1] neg_hi:[0,1]
    v_cvt_pk_bf16_f32 v65, v178, v179
    v_lshlrev_b32 v178, 16, v65
    v_and_b32 v179, s61, v65
    v_pk_mul_f32 v[178:179], v[178:179], v[208:209] op_sel_hi:[1,0]
    v_cvt_pk_bf16_f32 v65, v178, v179
    v_pk_add_f32 v[180:181], v[180:181], v[210:211] op_sel_hi:[1,0] neg_lo:[0,1] neg_hi:[0,1]
    v_cvt_pk_bf16_f32 v66, v180, v181
    v_lshlrev_b32 v180, 16, v66
    v_and_b32 v181, s61, v66
    v_pk_mul_f32 v[180:181], v[180:181], v[208:209] op_sel_hi:[1,0]
    v_cvt_pk_bf16_f32 v66, v180, v181
    v_pk_add_f32 v[182:183], v[182:183], v[210:211] op_sel_hi:[1,0] neg_lo:[0,1] neg_hi:[0,1]
    v_cvt_pk_bf16_f32 v67, v182, v183
    v_lshlrev_b32 v182, 16, v67
    v_and_b32 v183, s61, v67
    v_pk_mul_f32 v[182:183], v[182:183], v[208:209] op_sel_hi:[1,0]
    v_cvt_pk_bf16_f32 v67, v182, v183
    buffer_store_dwordx4 v[64:67], v1, s[4:7], s56 offen offset:0 sc1
    v_pk_add_f32 v[184:185], v[184:185], v[210:211] op_sel_hi:[1,0] neg_lo:[0,1] neg_hi:[0,1]
    v_cvt_pk_bf16_f32 v68, v184, v185
    v_lshlrev_b32 v184, 16, v68
    v_and_b32 v185, s61, v68
    v_pk_mul_f32 v[184:185], v[184:185], v[208:209] op_sel_hi:[1,0]
    v_cvt_pk_bf16_f32 v68, v184, v185
    v_pk_add_f32 v[186:187], v[186:187], v[210:211] op_sel_hi:[1,0] neg_lo:[0,1] neg_hi:[0,1]
    v_cvt_pk_bf16_f32 v69, v186, v187
    v_lshlrev_b32 v186, 16, v69
    v_and_b32 v187, s61, v69
    v_pk_mul_f32 v[186:187], v[186:187], v[208:209] op_sel_hi:[1,0]
    v_cvt_pk_bf16_f32 v69, v186, v187
    v_pk_add_f32 v[188:189], v[188:189], v[210:211] op_sel_hi:[1,0] neg_lo:[0,1] neg_hi:[0,1]
    v_cvt_pk_bf16_f32 v70, v188, v189
    v_lshlrev_b32 v188, 16, v70
    v_and_b32 v189, s61, v70
    v_pk_mul_f32 v[188:189], v[188:189], v[208:209] op_sel_hi:[1,0]
    v_cvt_pk_bf16_f32 v70, v188, v189
    v_pk_add_f32 v[190:191], v[190:191], v[210:211] op_sel_hi:[1,0] neg_lo:[0,1] neg_hi:[0,1]
    v_cvt_pk_bf16_f32 v71, v190, v191
    v_lshlrev_b32 v190, 16, v71
    v_and_b32 v191, s61, v71
    v_pk_mul_f32 v[190:191], v[190:191], v[208:209] op_sel_hi:[1,0]
    v_cvt_pk_bf16_f32 v71, v190, v191
    buffer_store_dwordx4 v[68:71], v1, s[4:7], s56 offen offset:1024 sc1
    v_pk_add_f32 v[192:193], v[192:193], v[210:211] op_sel_hi:[1,0] neg_lo:[0,1] neg_hi:[0,1]
    v_cvt_pk_bf16_f32 v72, v192, v193
    v_lshlrev_b32 v192, 16, v72
    v_and_b32 v193, s61, v72
    v_pk_mul_f32 v[192:193], v[192:193], v[208:209] op_sel_hi:[1,0]
    v_cvt_pk_bf16_f32 v72, v192, v193
    v_pk_add_f32 v[194:195], v[194:195], v[210:211] op_sel_hi:[1,0] neg_lo:[0,1] neg_hi:[0,1]
    v_cvt_pk_bf16_f32 v73, v194, v195
    v_lshlrev_b32 v194, 16, v73
    v_and_b32 v195, s61, v73
    v_pk_mul_f32 v[194:195], v[194:195], v[208:209] op_sel_hi:[1,0]
    v_cvt_pk_bf16_f32 v73, v194, v195
    v_pk_add_f32 v[196:197], v[196:197], v[210:211] op_sel_hi:[1,0] neg_lo:[0,1] neg_hi:[0,1]
    v_cvt_pk_bf16_f32 v74, v196, v197
    v_lshlrev_b32 v196, 16, v74
    v_and_b32 v197, s61, v74
    v_pk_mul_f32 v[196:197], v[196:197], v[208:209] op_sel_hi:[1,0]
    v_cvt_pk_bf16_f32 v74, v196, v197
    v_pk_add_f32 v[198:199], v[198:199], v[210:211] op_sel_hi:[1,0] neg_lo:[0,1] neg_hi:[0,1]
    v_cvt_pk_bf16_f32 v75, v198, v199
    v_lshlrev_b32 v198, 16, v75
    v_and_b32 v199, s61, v75
    v_pk_mul_f32 v[198:199], v[198:199], v[208:209] op_sel_hi:[1,0]
    v_cvt_pk_bf16_f32 v75, v198, v199
    buffer_store_dwordx4 v[72:75], v1, s[4:7], s56 offen offset:2048 sc1
    v_pk_add_f32 v[200:201], v[200:201], v[210:211] op_sel_hi:[1,0] neg_lo:[0,1] neg_hi:[0,1]
    v_cvt_pk_bf16_f32 v76, v200, v201
    v_lshlrev_b32 v200, 16, v76
    v_and_b32 v201, s61, v76
    v_pk_mul_f32 v[200:201], v[200:201], v[208:209] op_sel_hi:[1,0]
    v_cvt_pk_bf16_f32 v76, v200, v201
    v_pk_add_f32 v[202:203], v[202:203], v[210:211] op_sel_hi:[1,0] neg_lo:[0,1] neg_hi:[0,1]
    v_cvt_pk_bf16_f32 v77, v202, v203
    v_lshlrev_b32 v202, 16, v77
    v_and_b32 v203, s61, v77
    v_pk_mul_f32 v[202:203], v[202:203], v[208:209] op_sel_hi:[1,0]
    v_cvt_pk_bf16_f32 v77, v202, v203
    v_pk_add_f32 v[204:205], v[204:205], v[210:211] op_sel_hi:[1,0] neg_lo:[0,1] neg_hi:[0,1]
    v_cvt_pk_bf16_f32 v78, v204, v205
    v_lshlrev_b32 v204, 16, v78
    v_and_b32 v205, s61, v78
    v_pk_mul_f32 v[204:205], v[204:205], v[208:209] op_sel_hi:[1,0]
    v_cvt_pk_bf16_f32 v78, v204, v205
    v_pk_add_f32 v[206:207], v[206:207], v[210:211] op_sel_hi:[1,0] neg_lo:[0,1] neg_hi:[0,1]
    v_cvt_pk_bf16_f32 v79, v206, v207
    v_lshlrev_b32 v206, 16, v79
    v_and_b32 v207, s61, v79
    v_pk_mul_f32 v[206:207], v[206:207], v[208:209] op_sel_hi:[1,0]
    v_cvt_pk_bf16_f32 v79, v206, v207
    buffer_store_dwordx4 v[76:79], v1, s[4:7], s56 offen offset:3072 sc1
    s_add_u32 s56, s56, 4096
    v_mov_b32 v12, 0
L_wf_12:
    buffer_load_dword v11, v12, s[8:11], 0 offen offset:16 sc1
    s_waitcnt vmcnt(0)
    v_cmp_ge_u32 vcc, 0, v11
    s_cbranch_vccz L_wfd_13
    s_sub_u32 s59, s59, 1
    s_cbranch_scc1 L_timeout
    s_sleep 2
    s_branch L_wf_12
L_wfd_13:
    s_lshl_b32 s56, s60, 2
    s_add_u32 s56, s56, 0
    v_mov_b32 v11, 1
    s_mov_b64 exec, 1
    buffer_store_dword v11, v12, s[4:7], s56 offen sc1
    s_mov_b64 exec, -1
    s_branch L_end
L_glu:
    v_mov_b32 v8, v0
    v_lshrrev_b32 v9, 4, v8
    v_and_b32 v10, 15, v8
    s_sub_u32 s61, s53, 128
    s_mul_hi_u32 s60, s61, 0x1745d175
    s_mul_i32 s55, s60, 11
    s_sub_u32 s61, s61, s55
    s_lshl_b32 s66, s61, 2
    s_add_u32 s66, s66, s52
    s_min_u32 s66, s66, 42
    s_lshl_b32 s65, s66, 6
    s_mov_b32 s62, s60
    s_lshl_b32 s55, s60, 7
    s_lshl_b32 s56, s61, 2
    s_add_u32 s67, s55, s56
    s_add_u32 s67, s67, 1024
    v_lshlrev_b32 v1, 4, v8
    v_lshrrev_b32 v11, 5, v8
    v_lshlrev_b32 v11, 1, v11
    v_and_b32 v12, 3, v8
    v_xor_b32 v11, v11, v12
    v_lshlrev_b32 v13, 4, v11
    v_lshrrev_b32 v11, 2, v10
    v_lshl_add_u32 v11, v9, 3, v11
    v_lshlrev_b32 v11, 6, v11
    v_and_b32 v12, 3, v10
    v_lshl_add_u32 v11, v12, 3, v11
    v_and_b32 v12, 1, v9
    v_lshl_add_u32 v11, v12, 5, v11
    s_lshl_b32 s58, s52, 15
    v_add_u32 v14, s58, v11
    v_xor_b32 v15, 32, v14
    v_lshrrev_b32 v12, 2, v8
    v_mul_u32_u24 v12, 2752, v12
    v_add_u32 v13, v12, v13
    s_add_u32 m0, s58, 0
    s_add_u32 s55, s65, 0
    buffer_load_dwordx4 v13, s[36:39], s55 offen lds
    s_add_u32 m0, s58, 1024
    s_add_u32 s55, s65, 44032
    buffer_load_dwordx4 v13, s[36:39], s55 offen lds
    s_add_u32 m0, s58, 2048
    s_add_u32 s55, s65, 88064
    buffer_load_dwordx4 v13, s[36:39], s55 offen lds
    s_add_u32 m0, s58, 3072
    s_add_u32 s55, s65, 132096
    buffer_load_dwordx4 v13, s[36:39], s55 offen lds
    s_add_u32 m0, s58, 4096
    s_add_u32 s55, s65, 176128
    buffer_load_dwordx4 v13, s[36:39], s55 offen lds
    s_add_u32 m0, s58, 5120
    s_add_u32 s55, s65, 220160
    buffer_load_dwordx4 v13, s[36:39], s55 offen lds
    s_add_u32 m0, s58, 6144
    s_add_u32 s55, s65, 264192
    buffer_load_dwordx4 v13, s[36:39], s55 offen lds
    s_add_u32 m0, s58, 7168
    s_add_u32 s55, s65, 308224
    buffer_load_dwordx4 v13, s[36:39], s55 offen lds
    s_add_u32 m0, s58, 8192
    s_add_u32 s55, s65, 352256
    buffer_load_dwordx4 v13, s[36:39], s55 offen lds
    s_add_u32 m0, s58, 9216
    s_add_u32 s55, s65, 396288
    buffer_load_dwordx4 v13, s[36:39], s55 offen lds
    s_add_u32 m0, s58, 10240
    s_add_u32 s55, s65, 440320
    buffer_load_dwordx4 v13, s[36:39], s55 offen lds
    s_add_u32 m0, s58, 11264
    s_add_u32 s55, s65, 484352
    buffer_load_dwordx4 v13, s[36:39], s55 offen lds
    s_add_u32 m0, s58, 12288
    s_add_u32 s55, s65, 528384
    buffer_load_dwordx4 v13, s[36:39], s55 offen lds
    s_add_u32 m0, s58, 13312
    s_add_u32 s55, s65, 572416
    buffer_load_dwordx4 v13, s[36:39], s55 offen lds
    s_add_u32 m0, s58, 14336
    s_add_u32 s55, s65, 616448
    buffer_load_dwordx4 v13, s[36:39], s55 offen lds
    s_add_u32 m0, s58, 15360
    s_add_u32 s55, s65, 660480
    buffer_load_dwordx4 v13, s[36:39], s55 offen lds
    s_add_u32 m0, s58, 16384
    s_add_u32 s55, s65, 704512
    buffer_load_dwordx4 v13, s[36:39], s55 offen lds
    s_add_u32 m0, s58, 17408
    s_add_u32 s55, s65, 748544
    buffer_load_dwordx4 v13, s[36:39], s55 offen lds
    s_add_u32 m0, s58, 18432
    s_add_u32 s55, s65, 792576
    buffer_load_dwordx4 v13, s[36:39], s55 offen lds
    s_add_u32 m0, s58, 19456
    s_add_u32 s55, s65, 836608
    buffer_load_dwordx4 v13, s[36:39], s55 offen lds
    s_add_u32 m0, s58, 20480
    s_add_u32 s55, s65, 880640
    buffer_load_dwordx4 v13, s[36:39], s55 offen lds
    s_add_u32 m0, s58, 21504
    s_add_u32 s55, s65, 924672
    buffer_load_dwordx4 v13, s[36:39], s55 offen lds
    s_add_u32 m0, s58, 22528
    s_add_u32 s55, s65, 968704
    buffer_load_dwordx4 v13, s[36:39], s55 offen lds
    s_add_u32 m0, s58, 23552
    s_add_u32 s55, s65, 1012736
    buffer_load_dwordx4 v13, s[36:39], s55 offen lds
    s_add_u32 m0, s58, 24576
    s_add_u32 s55, s65, 1056768
    buffer_load_dwordx4 v13, s[36:39], s55 offen lds
    s_add_u32 m0, s58, 25600
    s_add_u32 s55, s65, 1100800
    buffer_load_dwordx4 v13, s[36:39], s55 offen lds
    s_add_u32 m0, s58, 26624
    s_add_u32 s55, s65, 1144832
    buffer_load_dwordx4 v13, s[36:39], s55 offen lds
    s_add_u32 m0, s58, 27648
    s_add_u32 s55, s65, 1188864
    buffer_load_dwordx4 v13, s[36:39], s55 offen lds
    s_add_u32 m0, s58, 28672
    s_add_u32 s55, s65, 1232896
    buffer_load_dwordx4 v13, s[36:39], s55 offen lds
    s_add_u32 m0, s58, 29696
    s_add_u32 s55, s65, 1276928
    buffer_load_dwordx4 v13, s[36:39], s55 offen lds
    s_add_u32 m0, s58, 30720
    s_add_u32 s55, s65, 1320960
    buffer_load_dwordx4 v13, s[36:39], s55 offen lds
    s_add_u32 m0, s58, 31744
    s_add_u32 s55, s65, 1364992
    buffer_load_dwordx4 v13, s[36:39], s55 offen lds
    s_waitcnt vmcnt(28)
    ds_read_b64_tr_b16 a[0:1], v14 offset:0
    ds_read_b64_tr_b16 a[2:3], v14 offset:256
    ds_read_b64_tr_b16 a[4:5], v14 offset:2048
    ds_read_b64_tr_b16 a[6:7], v14 offset:2304
    ds_read_b64_tr_b16 a[8:9], v15 offset:0
    ds_read_b64_tr_b16 a[10:11], v15 offset:256
    ds_read_b64_tr_b16 a[12:13], v15 offset:2048
    ds_read_b64_tr_b16 a[14:15], v15 offset:2304
    s_waitcnt lgkmcnt(0)
    s_add_u32 m0, s58, 0
    s_add_u32 s55, s65, 0
    buffer_load_dwordx4 v13, s[40:43], s55 offen lds
    s_add_u32 m0, s58, 1024
    s_add_u32 s55, s65, 44032
    buffer_load_dwordx4 v13, s[40:43], s55 offen lds
    s_add_u32 m0, s58, 2048
    s_add_u32 s55, s65, 88064
    buffer_load_dwordx4 v13, s[40:43], s55 offen lds
    s_add_u32 m0, s58, 3072
    s_add_u32 s55, s65, 132096
    buffer_load_dwordx4 v13, s[40:43], s55 offen lds
    s_waitcnt vmcnt(28)
    ds_read_b64_tr_b16 a[16:17], v14 offset:4096
    ds_read_b64_tr_b16 a[18:19], v14 offset:4352
    ds_read_b64_tr_b16 a[20:21], v14 offset:6144
    ds_read_b64_tr_b16 a[22:23], v14 offset:6400
    ds_read_b64_tr_b16 a[24:25], v15 offset:4096
    ds_read_b64_tr_b16 a[26:27], v15 offset:4352
    ds_read_b64_tr_b16 a[28:29], v15 offset:6144
    ds_read_b64_tr_b16 a[30:31], v15 offset:6400
    s_waitcnt lgkmcnt(0)
    s_add_u32 m0, s58, 4096
    s_add_u32 s55, s65, 176128
    buffer_load_dwordx4 v13, s[40:43], s55 offen lds
    s_add_u32 m0, s58, 5120
    s_add_u32 s55, s65, 220160
    buffer_load_dwordx4 v13, s[40:43], s55 offen lds
    s_add_u32 m0, s58, 6144
    s_add_u32 s55, s65, 264192
    buffer_load_dwordx4 v13, s[40:43], s55 offen lds
    s_add_u32 m0, s58, 7168
    s_add_u32 s55, s65, 308224
    buffer_load_dwordx4 v13, s[40:43], s55 offen lds
    s_waitcnt vmcnt(28)
    ds_read_b64_tr_b16 a[32:33], v14 offset:8192
    ds_read_b64_tr_b16 a[34:35], v14 offset:8448
    ds_read_b64_tr_b16 a[36:37], v14 offset:10240
    ds_read_b64_tr_b16 a[38:39], v14 offset:10496
    ds_read_b64_tr_b16 a[40:41], v15 offset:8192
    ds_read_b64_tr_b16 a[42:43], v15 offset:8448
    ds_read_b64_tr_b16 a[44:45], v15 offset:10240
    ds_read_b64_tr_b16 a[46:47], v15 offset:10496
    s_waitcnt lgkmcnt(0)
    s_add_u32 m0, s58, 8192
    s_add_u32 s55, s65, 352256
    buffer_load_dwordx4 v13, s[40:43], s55 offen lds
    s_add_u32 m0, s58, 9216
    s_add_u32 s55, s65, 396288
    buffer_load_dwordx4 v13, s[40:43], s55 offen lds
    s_add_u32 m0, s58, 10240
    s_add_u32 s55, s65, 440320
    buffer_load_dwordx4 v13, s[40:43], s55 offen lds
    s_add_u32 m0, s58, 11264
    s_add_u32 s55, s65, 484352
    buffer_load_dwordx4 v13, s[40:43], s55 offen lds
    s_waitcnt vmcnt(28)
    ds_read_b64_tr_b16 a[48:49], v14 offset:12288
    ds_read_b64_tr_b16 a[50:51], v14 offset:12544
    ds_read_b64_tr_b16 a[52:53], v14 offset:14336
    ds_read_b64_tr_b16 a[54:55], v14 offset:14592
    ds_read_b64_tr_b16 a[56:57], v15 offset:12288
    ds_read_b64_tr_b16 a[58:59], v15 offset:12544
    ds_read_b64_tr_b16 a[60:61], v15 offset:14336
    ds_read_b64_tr_b16 a[62:63], v15 offset:14592
    s_waitcnt lgkmcnt(0)
    s_add_u32 m0, s58, 12288
    s_add_u32 s55, s65, 528384
    buffer_load_dwordx4 v13, s[40:43], s55 offen lds
    s_add_u32 m0, s58, 13312
    s_add_u32 s55, s65, 572416
    buffer_load_dwordx4 v13, s[40:43], s55 offen lds
    s_add_u32 m0, s58, 14336
    s_add_u32 s55, s65, 616448
    buffer_load_dwordx4 v13, s[40:43], s55 offen lds
    s_add_u32 m0, s58, 15360
    s_add_u32 s55, s65, 660480
    buffer_load_dwordx4 v13, s[40:43], s55 offen lds
    s_waitcnt vmcnt(28)
    ds_read_b64_tr_b16 a[64:65], v14 offset:16384
    ds_read_b64_tr_b16 a[66:67], v14 offset:16640
    ds_read_b64_tr_b16 a[68:69], v14 offset:18432
    ds_read_b64_tr_b16 a[70:71], v14 offset:18688
    ds_read_b64_tr_b16 a[72:73], v15 offset:16384
    ds_read_b64_tr_b16 a[74:75], v15 offset:16640
    ds_read_b64_tr_b16 a[76:77], v15 offset:18432
    ds_read_b64_tr_b16 a[78:79], v15 offset:18688
    s_waitcnt lgkmcnt(0)
    s_add_u32 m0, s58, 16384
    s_add_u32 s55, s65, 704512
    buffer_load_dwordx4 v13, s[40:43], s55 offen lds
    s_add_u32 m0, s58, 17408
    s_add_u32 s55, s65, 748544
    buffer_load_dwordx4 v13, s[40:43], s55 offen lds
    s_add_u32 m0, s58, 18432
    s_add_u32 s55, s65, 792576
    buffer_load_dwordx4 v13, s[40:43], s55 offen lds
    s_add_u32 m0, s58, 19456
    s_add_u32 s55, s65, 836608
    buffer_load_dwordx4 v13, s[40:43], s55 offen lds
    s_waitcnt vmcnt(28)
    ds_read_b64_tr_b16 a[80:81], v14 offset:20480
    ds_read_b64_tr_b16 a[82:83], v14 offset:20736
    ds_read_b64_tr_b16 a[84:85], v14 offset:22528
    ds_read_b64_tr_b16 a[86:87], v14 offset:22784
    ds_read_b64_tr_b16 a[88:89], v15 offset:20480
    ds_read_b64_tr_b16 a[90:91], v15 offset:20736
    ds_read_b64_tr_b16 a[92:93], v15 offset:22528
    ds_read_b64_tr_b16 a[94:95], v15 offset:22784
    s_waitcnt lgkmcnt(0)
    s_add_u32 m0, s58, 20480
    s_add_u32 s55, s65, 880640
    buffer_load_dwordx4 v13, s[40:43], s55 offen lds
    s_add_u32 m0, s58, 21504
    s_add_u32 s55, s65, 924672
    buffer_load_dwordx4 v13, s[40:43], s55 offen lds
    s_add_u32 m0, s58, 22528
    s_add_u32 s55, s65, 968704
    buffer_load_dwordx4 v13, s[40:43], s55 offen lds
    s_add_u32 m0, s58, 23552
    s_add_u32 s55, s65, 1012736
    buffer_load_dwordx4 v13, s[40:43], s55 offen lds
    s_waitcnt vmcnt(28)
    ds_read_b64_tr_b16 a[96:97], v14 offset:24576
    ds_read_b64_tr_b16 a[98:99], v14 offset:24832
    ds_read_b64_tr_b16 a[100:101], v14 offset:26624
    ds_read_b64_tr_b16 a[102:103], v14 offset:26880
    ds_read_b64_tr_b16 a[104:105], v15 offset:24576
    ds_read_b64_tr_b16 a[106:107], v15 offset:24832
    ds_read_b64_tr_b16 a[108:109], v15 offset:26624
    ds_read_b64_tr_b16 a[110:111], v15 offset:26880
    s_waitcnt lgkmcnt(0)
    s_add_u32 m0, s58, 24576
    s_add_u32 s55, s65, 1056768
    buffer_load_dwordx4 v13, s[40:43], s55 offen lds
    s_add_u32 m0, s58, 25600
    s_add_u32 s55, s65, 1100800
    buffer_load_dwordx4 v13, s[40:43], s55 offen lds
    s_add_u32 m0, s58, 26624
    s_add_u32 s55, s65, 1144832
    buffer_load_dwordx4 v13, s[40:43], s55 offen lds
    s_add_u32 m0, s58, 27648
    s_add_u32 s55, s65, 1188864
    buffer_load_dwordx4 v13, s[40:43], s55 offen lds
    s_waitcnt vmcnt(28)
    ds_read_b64_tr_b16 a[112:113], v14 offset:28672
    ds_read_b64_tr_b16 a[114:115], v14 offset:28928
    ds_read_b64_tr_b16 a[116:117], v14 offset:30720
    ds_read_b64_tr_b16 a[118:119], v14 offset:30976
    ds_read_b64_tr_b16 a[120:121], v15 offset:28672
    ds_read_b64_tr_b16 a[122:123], v15 offset:28928
    ds_read_b64_tr_b16 a[124:125], v15 offset:30720
    ds_read_b64_tr_b16 a[126:127], v15 offset:30976
    s_waitcnt lgkmcnt(0)
    s_add_u32 m0, s58, 28672
    s_add_u32 s55, s65, 1232896
    buffer_load_dwordx4 v13, s[40:43], s55 offen lds
    s_add_u32 m0, s58, 29696
    s_add_u32 s55, s65, 1276928
    buffer_load_dwordx4 v13, s[40:43], s55 offen lds
    s_add_u32 m0, s58, 30720
    s_add_u32 s55, s65, 1320960
    buffer_load_dwordx4 v13, s[40:43], s55 offen lds
    s_add_u32 m0, s58, 31744
    s_add_u32 s55, s65, 1364992
    buffer_load_dwordx4 v13, s[40:43], s55 offen lds
    s_waitcnt vmcnt(28)
    ds_read_b64_tr_b16 a[128:129], v14 offset:0
    ds_read_b64_tr_b16 a[130:131], v14 offset:256
    ds_read_b64_tr_b16 a[132:133], v14 offset:2048
    ds_read_b64_tr_b16 a[134:135], v14 offset:2304
    ds_read_b64_tr_b16 a[136:137], v15 offset:0
    ds_read_b64_tr_b16 a[138:139], v15 offset:256
    ds_read_b64_tr_b16 a[140:141], v15 offset:2048
    ds_read_b64_tr_b16 a[142:143], v15 offset:2304
    s_waitcnt lgkmcnt(0)
    s_waitcnt vmcnt(24)
    ds_read_b64_tr_b16 a[144:145], v14 offset:4096
    ds_read_b64_tr_b16 a[146:147], v14 offset:4352
    ds_read_b64_tr_b16 a[148:149], v14 offset:6144
    ds_read_b64_tr_b16 a[150:151], v14 offset:6400
    ds_read_b64_tr_b16 a[152:153], v15 offset:4096
    ds_read_b64_tr_b16 a[154:155], v15 offset:4352
    ds_read_b64_tr_b16 a[156:157], v15 offset:6144
    ds_read_b64_tr_b16 a[158:159], v15 offset:6400
    s_waitcnt lgkmcnt(0)
    s_waitcnt vmcnt(20)
    ds_read_b64_tr_b16 a[160:161], v14 offset:8192
    ds_read_b64_tr_b16 a[162:163], v14 offset:8448
    ds_read_b64_tr_b16 a[164:165], v14 offset:10240
    ds_read_b64_tr_b16 a[166:167], v14 offset:10496
    ds_read_b64_tr_b16 a[168:169], v15 offset:8192
    ds_read_b64_tr_b16 a[170:171], v15 offset:8448
    ds_read_b64_tr_b16 a[172:173], v15 offset:10240
    ds_read_b64_tr_b16 a[174:175], v15 offset:10496
    s_waitcnt lgkmcnt(0)
    s_waitcnt vmcnt(16)
    ds_read_b64_tr_b16 a[176:177], v14 offset:12288
    ds_read_b64_tr_b16 a[178:179], v14 offset:12544
    ds_read_b64_tr_b16 a[180:181], v14 offset:14336
    ds_read_b64_tr_b16 a[182:183], v14 offset:14592
    ds_read_b64_tr_b16 a[184:185], v15 offset:12288
    ds_read_b64_tr_b16 a[186:187], v15 offset:12544
    ds_read_b64_tr_b16 a[188:189], v15 offset:14336
    ds_read_b64_tr_b16 a[190:191], v15 offset:14592
    s_waitcnt lgkmcnt(0)
    s_waitcnt vmcnt(12)
    ds_read_b64_tr_b16 a[192:193], v14 offset:16384
    ds_read_b64_tr_b16 a[194:195], v14 offset:16640
    ds_read_b64_tr_b16 a[196:197], v14 offset:18432
    ds_read_b64_tr_b16 a[198:199], v14 offset:18688
    ds_read_b64_tr_b16 a[200:201], v15 offset:16384
    ds_read_b64_tr_b16 a[202:203], v15 offset:16640
    ds_read_b64_tr_b16 a[204:205], v15 offset:18432
    ds_read_b64_tr_b16 a[206:207], v15 offset:18688
    s_waitcnt lgkmcnt(0)
    s_waitcnt vmcnt(8)
    ds_read_b64_tr_b16 a[208:209], v14 offset:20480
    ds_read_b64_tr_b16 a[210:211], v14 offset:20736
    ds_read_b64_tr_b16 a[212:213], v14 offset:22528
    ds_read_b64_tr_b16 a[214:215], v14 offset:22784
    ds_read_b64_tr_b16 a[216:217], v15 offset:20480
    ds_read_b64_tr_b16 a[218:219], v15 offset:20736
    ds_read_b64_tr_b16 a[220:221], v15 offset:22528
    ds_read_b64_tr_b16 a[222:223], v15 offset:22784
    s_waitcnt lgkmcnt(0)
    s_waitcnt vmcnt(4)
    ds_read_b64_tr_b16 a[224:225], v14 offset:24576
    ds_read_b64_tr_b16 a[226:227], v14 offset:24832
    ds_read_b64_tr_b16 a[228:229], v14 offset:26624
    ds_read_b64_tr_b16 a[230:231], v14 offset:26880
    ds_read_b64_tr_b16 a[232:233], v15 offset:24576
    ds_read_b64_tr_b16 a[234:235], v15 offset:24832
    ds_read_b64_tr_b16 a[236:237], v15 offset:26624
    ds_read_b64_tr_b16 a[238:239], v15 offset:26880
    s_waitcnt lgkmcnt(0)
    s_waitcnt vmcnt(0)
    ds_read_b64_tr_b16 a[240:241], v14 offset:28672
    ds_read_b64_tr_b16 a[242:243], v14 offset:28928
    ds_read_b64_tr_b16 a[244:245], v14 offset:30720
    ds_read_b64_tr_b16 a[246:247], v14 offset:30976
    ds_read_b64_tr_b16 a[248:249], v15 offset:28672
    ds_read_b64_tr_b16 a[250:251], v15 offset:28928
    ds_read_b64_tr_b16 a[252:253], v15 offset:30720
    ds_read_b64_tr_b16 a[254:255], v15 offset:30976
    s_waitcnt lgkmcnt(0)
    v_mov_b32 v12, 0
L_wf_14:
    buffer_load_dword v11, v12, s[8:11], 0 offen offset:16 sc1
    s_waitcnt vmcnt(0)
    v_cmp_ge_u32 vcc, 0, v11
    s_cbranch_vccz L_wfd_15
    s_sub_u32 s59, s59, 1
    s_cbranch_scc1 L_timeout
    s_sleep 2
    s_branch L_wf_14
L_wfd_15:
    v_lshlrev_b32 v12, 2, v8
    s_mov_b32 s56, 0
L_wf_16:
    buffer_load_dword v11, v12, s[4:7], s56 offen offset:0 sc1
    s_waitcnt vmcnt(0)
    v_cmp_ge_u32 vcc, 0, v11
    s_cbranch_vccz L_wfd_17
    s_sub_u32 s59, s59, 1
    s_cbranch_scc1 L_timeout
    s_sleep 2
    s_branch L_wf_16
L_wfd_17:
L_wf_18:
    buffer_load_dword v11, v12, s[4:7], s56 offen offset:256 sc1
    s_waitcnt vmcnt(0)
    v_cmp_ge_u32 vcc, 0, v11
    s_cbranch_vccz L_wfd_19
    s_sub_u32 s59, s59, 1
    s_cbranch_scc1 L_timeout
    s_sleep 2
    s_branch L_wf_18
L_wfd_19:
    s_barrier
    s_lshl_b32 s56, s52, 13
    s_lshl_b32 s63, s60, 15
    s_add_u32 s63, s63, s56
    s_add_u32 s63, s63, 0x200000
    s_mov_b32 s64, s56
    v_mov_b32 v2, v1
    s_mul_i32 s68, s60, 88064
    s_lshl_b32 s55, s66, 10
    s_add_u32 s68, s68, s55
    s_add_u32 s68, s68, 0x400000
    s_add_u32 m0, s64, 0
    s_add_u32 s55, s63, 0
    buffer_load_dwordx4 v1, s[4:7], s55 offen sc1 lds
    buffer_load_dwordx4 v1, s[4:7], s55 offen offset:1024 sc1 lds
    buffer_load_dwordx4 v1, s[4:7], s55 offen offset:2048 sc1 lds
    buffer_load_dwordx4 v1, s[4:7], s55 offen offset:3072 sc1 lds
    s_add_u32 m0, s64, 4096
    s_add_u32 s55, s63, 4096
    buffer_load_dwordx4 v1, s[4:7], s55 offen sc1 lds
    buffer_load_dwordx4 v1, s[4:7], s55 offen offset:1024 sc1 lds
    buffer_load_dwordx4 v1, s[4:7], s55 offen offset:2048 sc1 lds
    buffer_load_dwordx4 v1, s[4:7], s55 offen offset:3072 sc1 lds
    s_waitcnt vmcnt(0)
    s_barrier
L_g_loop:
    s_add_u32 s63, s63, 262144
    s_xor_b32 s64, s64, 32768
    ds_read_b128 v[64:67], v2 offset:0
    ds_read_b128 v[68:71], v2 offset:16384
    ds_read_b128 v[72:75], v2 offset:1024
    ds_read_b128 v[76:79], v2 offset:17408
    s_waitcnt lgkmcnt(2)
    v_mfma_f32_16x16x32_bf16 v[16:19], a[0:3], v[64:67], 0
    ds_read_b128 v[80:83], v2 offset:2048
    v_mfma_f32_16x16x32_bf16 v[20:23], a[0:3], v[68:71], 0
    ds_read_b128 v[84:87], v2 offset:18432
    v_mfma_f32_16x16x32_bf16 v[32:35], a[128:131], v[64:67], 0
    v_mfma_f32_16x16x32_bf16 v[36:39], a[128:131], v[68:71], 0
    v_mfma_f32_16x16x32_bf16 v[24:27], a[8:11], v[64:67], 0
    s_add_u32 m0, s64, 0
    s_add_u32 s55, s63, 0
    buffer_load_dwordx4 v1, s[4:7], s55 offen sc1 lds
    v_mfma_f32_16x16x32_bf16 v[28:31], a[8:11], v[68:71], 0
    v_mfma_f32_16x16x32_bf16 v[40:43], a[136:139], v[64:67], 0
    v_mfma_f32_16x16x32_bf16 v[44:47], a[136:139], v[68:71], 0
    s_waitcnt lgkmcnt(2)
    v_mfma_f32_16x16x32_bf16 v[16:19], a[4:7], v[72:75], v[16:19]
    ds_read_b128 v[64:67], v2 offset:3072
    v_mfma_f32_16x16x32_bf16 v[20:23], a[4:7], v[76:79], v[20:23]
    ds_read_b128 v[68:71], v2 offset:19456
    v_mfma_f32_16x16x32_bf16 v[32:35], a[132:135], v[72:75], v[32:35]
    v_mfma_f32_16x16x32_bf16 v[36:39], a[132:135], v[76:79], v[36:39]
    v_mfma_f32_16x16x32_bf16 v[24:27], a[12:15], v[72:75], v[24:27]
    buffer_load_dwordx4 v1, s[4:7], s55 offen offset:1024 sc1 lds
    v_mfma_f32_16x16x32_bf16 v[28:31], a[12:15], v[76:79], v[28:31]
    v_mfma_f32_16x16x32_bf16 v[40:43], a[140:143], v[72:75], v[40:43]
    v_mfma_f32_16x16x32_bf16 v[44:47], a[140:143], v[76:79], v[44:47]
    s_waitcnt lgkmcnt(2)
    v_mfma_f32_16x16x32_bf16 v[16:19], a[16:19], v[80:83], v[16:19]
    ds_read_b128 v[72:75], v2 offset:4096
    v_mfma_f32_16x16x32_bf16 v[20:23], a[16:19], v[84:87], v[20:23]
    ds_read_b128 v[76:79], v2 offset:20480
    v_mfma_f32_16x16x32_bf16 v[32:35], a[144:147], v[80:83], v[32:35]
    v_mfma_f32_16x16x32_bf16 v[36:39], a[144:147], v[84:87], v[36:39]
    v_mfma_f32_16x16x32_bf16 v[24:27], a[24:27], v[80:83], v[24:27]
    buffer_load_dwordx4 v1, s[4:7], s55 offen offset:2048 sc1 lds
    v_mfma_f32_16x16x32_bf16 v[28:31], a[24:27], v[84:87], v[28:31]
    v_mfma_f32_16x16x32_bf16 v[40:43], a[152:155], v[80:83], v[40:43]
    v_mfma_f32_16x16x32_bf16 v[44:47], a[152:155], v[84:87], v[44:47]
    s_waitcnt lgkmcnt(2)
    v_mfma_f32_16x16x32_bf16 v[16:19], a[20:23], v[64:67], v[16:19]
    ds_read_b128 v[80:83], v2 offset:5120
    v_mfma_f32_16x16x32_bf16 v[20:23], a[20:23], v[68:71], v[20:23]
    ds_read_b128 v[84:87], v2 offset:21504
    v_mfma_f32_16x16x32_bf16 v[32:35], a[148:151], v[64:67], v[32:35]
    v_mfma_f32_16x16x32_bf16 v[36:39], a[148:151], v[68:71], v[36:39]
    v_mfma_f32_16x16x32_bf16 v[24:27], a[28:31], v[64:67], v[24:27]
    buffer_load_dwordx4 v1, s[4:7], s55 offen offset:3072 sc1 lds
    v_mfma_f32_16x16x32_bf16 v[28:31], a[28:31], v[68:71], v[28:31]
    v_mfma_f32_16x16x32_bf16 v[40:43], a[156:159], v[64:67], v[40:43]
    v_mfma_f32_16x16x32_bf16 v[44:47], a[156:159], v[68:71], v[44:47]
    s_waitcnt lgkmcnt(2)
    v_mfma_f32_16x16x32_bf16 v[16:19], a[32:35], v[72:75], v[16:19]
    ds_read_b128 v[64:67], v2 offset:6144
    v_mfma_f32_16x16x32_bf16 v[20:23], a[32:35], v[76:79], v[20:23]
    ds_read_b128 v[68:71], v2 offset:22528
    v_mfma_f32_16x16x32_bf16 v[32:35], a[160:163], v[72:75], v[32:35]
    v_mfma_f32_16x16x32_bf16 v[36:39], a[160:163], v[76:79], v[36:39]
    v_mfma_f32_16x16x32_bf16 v[24:27], a[40:43], v[72:75], v[24:27]
    s_add_u32 m0, s64, 4096
    s_add_u32 s55, s63, 4096
    buffer_load_dwordx4 v1, s[4:7], s55 offen sc1 lds
    v_mfma_f32_16x16x32_bf16 v[28:31], a[40:43], v[76:79], v[28:31]
    v_mfma_f32_16x16x32_bf16 v[40:43], a[168:171], v[72:75], v[40:43]
    v_mfma_f32_16x16x32_bf16 v[44:47], a[168:171], v[76:79], v[44:47]
    s_waitcnt lgkmcnt(2)
    v_mfma_f32_16x16x32_bf16 v[16:19], a[36:39], v[80:83], v[16:19]
    ds_read_b128 v[72:75], v2 offset:7168
    v_mfma_f32_16x16x32_bf16 v[20:23], a[36:39], v[84:87], v[20:23]
    ds_read_b128 v[76:79], v2 offset:23552
    v_mfma_f32_16x16x32_bf16 v[32:35], a[164:167], v[80:83], v[32:35]
    v_mfma_f32_16x16x32_bf16 v[36:39], a[164:167], v[84:87], v[36:39]
    v_mfma_f32_16x16x32_bf16 v[24:27], a[44:47], v[80:83], v[24:27]
    buffer_load_dwordx4 v1, s[4:7], s55 offen offset:1024 sc1 lds
    v_mfma_f32_16x16x32_bf16 v[28:31], a[44:47], v[84:87], v[28:31]
    v_mfma_f32_16x16x32_bf16 v[40:43], a[172:175], v[80:83], v[40:43]
    v_mfma_f32_16x16x32_bf16 v[44:47], a[172:175], v[84:87], v[44:47]
    s_waitcnt lgkmcnt(2)
    v_mfma_f32_16x16x32_bf16 v[16:19], a[48:51], v[64:67], v[16:19]
    ds_read_b128 v[80:83], v2 offset:8192
    v_mfma_f32_16x16x32_bf16 v[20:23], a[48:51], v[68:71], v[20:23]
    ds_read_b128 v[84:87], v2 offset:24576
    v_mfma_f32_16x16x32_bf16 v[32:35], a[176:179], v[64:67], v[32:35]
    v_mfma_f32_16x16x32_bf16 v[36:39], a[176:179], v[68:71], v[36:39]
    v_mfma_f32_16x16x32_bf16 v[24:27], a[56:59], v[64:67], v[24:27]
    buffer_load_dwordx4 v1, s[4:7], s55 offen offset:2048 sc1 lds
    v_mfma_f32_16x16x32_bf16 v[28:31], a[56:59], v[68:71], v[28:31]
    v_mfma_f32_16x16x32_bf16 v[40:43], a[184:187], v[64:67], v[40:43]
    v_mfma_f32_16x16x32_bf16 v[44:47], a[184:187], v[68:71], v[44:47]
    s_waitcnt lgkmcnt(2)
    v_mfma_f32_16x16x32_bf16 v[16:19], a[52:55], v[72:75], v[16:19]
    ds_read_b128 v[64:67], v2 offset:9216
    v_mfma_f32_16x16x32_bf16 v[20:23], a[52:55], v[76:79], v[20:23]
    ds_read_b128 v[68:71], v2 offset:25600
    v_mfma_f32_16x16x32_bf16 v[32:35], a[180:183], v[72:75], v[32:35]
    v_mfma_f32_16x16x32_bf16 v[36:39], a[180:183], v[76:79], v[36:39]
    v_mfma_f32_16x16x32_bf16 v[24:27], a[60:63], v[72:75], v[24:27]
    buffer_load_dwordx4 v1, s[4:7], s55 offen offset:3072 sc1 lds
    v_mfma_f32_16x16x32_bf16 v[28:31], a[60:63], v[76:79], v[28:31]
    v_mfma_f32_16x16x32_bf16 v[40:43], a[188:191], v[72:75], v[40:43]
    v_mfma_f32_16x16x32_bf16 v[44:47], a[188:191], v[76:79], v[44:47]
    s_waitcnt lgkmcnt(2)
    v_mfma_f32_16x16x32_bf16 v[16:19], a[64:67], v[80:83], v[16:19]
    ds_read_b128 v[72:75], v2 offset:10240
    v_mfma_f32_16x16x32_bf16 v[20:23], a[64:67], v[84:87], v[20:23]
    ds_read_b128 v[76:79], v2 offset:26624
    v_mfma_f32_16x16x32_bf16 v[32:35], a[192:195], v[80:83], v[32:35]
    v_mfma_f32_16x16x32_bf16 v[36:39], a[192:195], v[84:87], v[36:39]
    v_mfma_f32_16x16x32_bf16 v[24:27], a[72:75], v[80:83], v[24:27]
    v_mfma_f32_16x16x32_bf16 v[28:31], a[72:75], v[84:87], v[28:31]
    v_mfma_f32_16x16x32_bf16 v[40:43], a[200:203], v[80:83], v[40:43]
    v_mfma_f32_16x16x32_bf16 v[44:47], a[200:203], v[84:87], v[44:47]
    s_waitcnt lgkmcnt(2)
    v_mfma_f32_16x16x32_bf16 v[16:19], a[68:71], v[64:67], v[16:19]
    ds_read_b128 v[80:83], v2 offset:11264
    v_mfma_f32_16x16x32_bf16 v[20:23], a[68:71], v[68:71], v[20:23]
    ds_read_b128 v[84:87], v2 offset:27648
    v_mfma_f32_16x16x32_bf16 v[32:35], a[196:199], v[64:67], v[32:35]
    v_mfma_f32_16x16x32_bf16 v[36:39], a[196:199], v[68:71], v[36:39]
    v_mfma_f32_16x16x32_bf16 v[24:27], a[76:79], v[64:67], v[24:27]
    v_mfma_f32_16x16x32_bf16 v[28:31], a[76:79], v[68:71], v[28:31]
    v_mfma_f32_16x16x32_bf16 v[40:43], a[204:207], v[64:67], v[40:43]
    v_mfma_f32_16x16x32_bf16 v[44:47], a[204:207], v[68:71], v[44:47]
    s_waitcnt lgkmcnt(2)
    v_mfma_f32_16x16x32_bf16 v[16:19], a[80:83], v[72:75], v[16:19]
    ds_read_b128 v[64:67], v2 offset:12288
    v_mfma_f32_16x16x32_bf16 v[20:23], a[80:83], v[76:79], v[20:23]
    ds_read_b128 v[68:71], v2 offset:28672
    v_mfma_f32_16x16x32_bf16 v[32:35], a[208:211], v[72:75], v[32:35]
    v_mfma_f32_16x16x32_bf16 v[36:39], a[208:211], v[76:79], v[36:39]
    v_mfma_f32_16x16x32_bf16 v[24:27], a[88:91], v[72:75], v[24:27]
    v_mfma_f32_16x16x32_bf16 v[28:31], a[88:91], v[76:79], v[28:31]
    v_mfma_f32_16x16x32_bf16 v[40:43], a[216:219], v[72:75], v[40:43]
    v_mfma_f32_16x16x32_bf16 v[44:47], a[216:219], v[76:79], v[44:47]
    s_waitcnt lgkmcnt(2)
    v_mfma_f32_16x16x32_bf16 v[16:19], a[84:87], v[80:83], v[16:19]
    ds_read_b128 v[72:75], v2 offset:13312
    v_mfma_f32_16x16x32_bf16 v[20:23], a[84:87], v[84:87], v[20:23]
    ds_read_b128 v[76:79], v2 offset:29696
    v_mfma_f32_16x16x32_bf16 v[32:35], a[212:215], v[80:83], v[32:35]
    v_mfma_f32_16x16x32_bf16 v[36:39], a[212:215], v[84:87], v[36:39]
    v_mfma_f32_16x16x32_bf16 v[24:27], a[92:95], v[80:83], v[24:27]
    v_mfma_f32_16x16x32_bf16 v[28:31], a[92:95], v[84:87], v[28:31]
    v_mfma_f32_16x16x32_bf16 v[40:43], a[220:223], v[80:83], v[40:43]
    v_mfma_f32_16x16x32_bf16 v[44:47], a[220:223], v[84:87], v[44:47]
    s_waitcnt lgkmcnt(2)
    v_mfma_f32_16x16x32_bf16 v[16:19], a[96:99], v[64:67], v[16:19]
    ds_read_b128 v[80:83], v2 offset:14336
    v_mfma_f32_16x16x32_bf16 v[20:23], a[96:99], v[68:71], v[20:23]
    ds_read_b128 v[84:87], v2 offset:30720
    v_mfma_f32_16x16x32_bf16 v[32:35], a[224:227], v[64:67], v[32:35]
    v_mfma_f32_16x16x32_bf16 v[36:39], a[224:227], v[68:71], v[36:39]
    v_mfma_f32_16x16x32_bf16 v[24:27], a[104:107], v[64:67], v[24:27]
    v_mfma_f32_16x16x32_bf16 v[28:31], a[104:107], v[68:71], v[28:31]
    v_mfma_f32_16x16x32_bf16 v[40:43], a[232:235], v[64:67], v[40:43]
    v_mfma_f32_16x16x32_bf16 v[44:47], a[232:235], v[68:71], v[44:47]
    s_waitcnt lgkmcnt(2)
    v_mfma_f32_16x16x32_bf16 v[16:19], a[100:103], v[72:75], v[16:19]
    ds_read_b128 v[64:67], v2 offset:15360
    v_mfma_f32_16x16x32_bf16 v[20:23], a[100:103], v[76:79], v[20:23]
    ds_read_b128 v[68:71], v2 offset:31744
    v_mfma_f32_16x16x32_bf16 v[32:35], a[228:231], v[72:75], v[32:35]
    v_mfma_f32_16x16x32_bf16 v[36:39], a[228:231], v[76:79], v[36:39]
    v_mfma_f32_16x16x32_bf16 v[24:27], a[108:111], v[72:75], v[24:27]
    v_mfma_f32_16x16x32_bf16 v[28:31], a[108:111], v[76:79], v[28:31]
    v_mfma_f32_16x16x32_bf16 v[40:43], a[236:239], v[72:75], v[40:43]
    v_mfma_f32_16x16x32_bf16 v[44:47], a[236:239], v[76:79], v[44:47]
    s_waitcnt lgkmcnt(2)
    v_mfma_f32_16x16x32_bf16 v[16:19], a[112:115], v[80:83], v[16:19]
    v_mfma_f32_16x16x32_bf16 v[20:23], a[112:115], v[84:87], v[20:23]
    v_mfma_f32_16x16x32_bf16 v[32:35], a[240:243], v[80:83], v[32:35]
    v_mfma_f32_16x16x32_bf16 v[36:39], a[240:243], v[84:87], v[36:39]
    v_mfma_f32_16x16x32_bf16 v[24:27], a[120:123], v[80:83], v[24:27]
    v_mfma_f32_16x16x32_bf16 v[28:31], a[120:123], v[84:87], v[28:31]
    v_mfma_f32_16x16x32_bf16 v[40:43], a[248:251], v[80:83], v[40:43]
    v_mfma_f32_16x16x32_bf16 v[44:47], a[248:251], v[84:87], v[44:47]
    s_waitcnt lgkmcnt(0)
    v_mfma_f32_16x16x32_bf16 v[16:19], a[116:119], v[64:67], v[16:19]
    v_mfma_f32_16x16x32_bf16 v[20:23], a[116:119], v[68:71], v[20:23]
    v_mfma_f32_16x16x32_bf16 v[32:35], a[244:247], v[64:67], v[32:35]
    v_mfma_f32_16x16x32_bf16 v[36:39], a[244:247], v[68:71], v[36:39]
    v_mfma_f32_16x16x32_bf16 v[24:27], a[124:127], v[64:67], v[24:27]
    v_mfma_f32_16x16x32_bf16 v[28:31], a[124:127], v[68:71], v[28:31]
    v_mfma_f32_16x16x32_bf16 v[40:43], a[252:255], v[64:67], v[40:43]
    v_mfma_f32_16x16x32_bf16 v[44:47], a[252:255], v[68:71], v[44:47]
    v_xor_b32 v2, 0x8000, v2
    s_add_u32 s56, s68, 44032
    v_mul_f32 v16, v16, v32
    v_mul_f32 v17, v17, v33
    v_mul_f32 v18, v18, v34
    v_mul_f32 v19, v19, v35
    v_mul_f32 v20, v20, v36
    v_mul_f32 v21, v21, v37
    v_mul_f32 v22, v22, v38
    v_mul_f32 v23, v23, v39
    v_mul_f32 v24, v24, v40
    v_mul_f32 v25, v25, v41
    v_mul_f32 v26, v26, v42
    v_mul_f32 v27, v27, v43
    v_mul_f32 v28, v28, v44
    v_mul_f32 v29, v29, v45
    v_mul_f32 v30, v30, v46
    v_mul_f32 v31, v31, v47
    v_cvt_pk_bf16_f32 v88, v16, v17
    v_cvt_pk_bf16_f32 v89, v18, v19
    v_cvt_pk_bf16_f32 v90, v24, v25
    v_cvt_pk_bf16_f32 v91, v26, v27
    buffer_store_dwordx4 v[88:91], v1, s[4:7], s68 offen sc1
    v_cvt_pk_bf16_f32 v92, v20, v21
    v_cvt_pk_bf16_f32 v93, v22, v23
    v_cvt_pk_bf16_f32 v94, v28, v29
    v_cvt_pk_bf16_f32 v95, v30, v31
    buffer_store_dwordx4 v[92:95], v1, s[4:7], s56 offen sc1
    s_add_u32 s68, s68, 704512
    s_add_u32 s62, s62, 8
    s_waitcnt vmcnt(0)
    s_barrier
    s_cmp_lg_u32 s52, 0
    s_cbranch_scc1 L_fs_20
    v_mov_b32 v11, s62
    v_mov_b32 v12, 0
    s_mov_b64 exec, 1
    buffer_store_dword v11, v12, s[4:7], s67 offen sc1
    s_mov_b64 exec, -1
L_fs_20:
    s_cmp_lt_u32 s62, 64
    s_cbranch_scc1 L_g_loop
    s_branch L_fin
L_fin:
    v_mov_b32 v8, v0
    v_lshrrev_b32 v9, 4, v8
    v_and_b32 v10, 15, v8
    s_sub_u32 s60, s53, 128
    s_lshr_b32 s61, s60, 4
    s_and_b32 s62, s60, 15
    v_lshlrev_b32 v1, 4, v8
    v_lshrrev_b32 v11, 5, v8
    v_lshlrev_b32 v11, 1, v11
    v_and_b32 v12, 3, v8
    v_xor_b32 v11, v11, v12
    v_lshlrev_b32 v13, 4, v11
    v_lshrrev_b32 v11, 2, v10
    v_lshl_add_u32 v11, v9, 3, v11
    v_lshlrev_b32 v11, 6, v11
    v_and_b32 v12, 3, v10
    v_lshl_add_u32 v11, v12, 3, v11
    v_and_b32 v12, 1, v9
    v_lshl_add_u32 v11, v12, 5, v11
    s_lshl_b32 s58, s52, 15
    v_add_u32 v14, s58, v11
    v_xor_b32 v15, 32, v14
    v_and_b32 v12, 1, v9
    v_lshlrev_b32 v12, 4, v12
    v_lshrrev_b32 v11, 5, v8
    v_lshl_add_u32 v12, v11, 2, v12
    v_lshrrev_b32 v11, 2, v10
    v_add_u32 v12, v11, v12
    v_lshl_add_u32 v13, v12, 10, v13
    s_lshl_b32 s56, s62, 6
    s_lshl_b32 s64, s52, 20
    s_add_u32 s64, s64, s56
    s_mul_i32 s65, s52, 360448
    s_add_u32 s65, s65, s56
    s_add_u32 m0, s58, 0
    s_add_u32 s55, s65, 0
    buffer_load_dwordx4 v13, s[44:47], s55 offen lds
    s_add_u32 m0, s58, 1024
    s_add_u32 s55, s65, 8192
    buffer_load_dwordx4 v13, s[44:47], s55 offen lds
    s_add_u32 m0, s58, 2048
    s_add_u32 s55, s65, 32768
    buffer_load_dwordx4 v13, s[44:47], s55 offen lds
    s_add_u32 m0, s58, 3072
    s_add_u32 s55, s65, 40960
    buffer_load_dwordx4 v13, s[44:47], s55 offen lds
    s_add_u32 m0, s58, 4096
    s_add_u32 s55, s65, 65536
    buffer_load_dwordx4 v13, s[44:47], s55 offen lds
    s_add_u32 m0, s58, 5120
    s_add_u32 s55, s65, 73728
    buffer_load_dwordx4 v13, s[44:47], s55 offen lds
    s_add_u32 m0, s58, 6144
    s_add_u32 s55, s65, 98304
    buffer_load_dwordx4 v13, s[44:47], s55 offen lds
    s_add_u32 m0, s58, 7168
    s_add_u32 s55, s65, 106496
    buffer_load_dwordx4 v13, s[44:47], s55 offen lds
    s_add_u32 m0, s58, 8192
    s_add_u32 s55, s65, 131072
    buffer_load_dwordx4 v13, s[44:47], s55 offen lds
    s_add_u32 m0, s58, 9216
    s_add_u32 s55, s65, 139264
    buffer_load_dwordx4 v13, s[44:47], s55 offen lds
    s_add_u32 m0, s58, 10240
    s_add_u32 s55, s65, 163840
    buffer_load_dwordx4 v13, s[44:47], s55 offen lds
    s_add_u32 m0, s58, 11264
    s_add_u32 s55, s65, 172032
    buffer_load_dwordx4 v13, s[44:47], s55 offen lds
    s_add_u32 m0, s58, 12288
    s_add_u32 s55, s65, 196608
    buffer_load_dwordx4 v13, s[44:47], s55 offen lds
    s_add_u32 m0, s58, 13312
    s_add_u32 s55, s65, 204800
    buffer_load_dwordx4 v13, s[44:47], s55 offen lds
    s_add_u32 m0, s58, 14336
    s_add_u32 s55, s65, 229376
    buffer_load_dwordx4 v13, s[44:47], s55 offen lds
    s_add_u32 m0, s58, 15360
    s_add_u32 s55, s65, 237568
    buffer_load_dwordx4 v13, s[44:47], s55 offen lds
    s_add_u32 m0, s58, 16384
    s_add_u32 s55, s65, 262144
    buffer_load_dwordx4 v13, s[44:47], s55 offen lds
    s_add_u32 m0, s58, 17408
    s_add_u32 s55, s65, 270336
    buffer_load_dwordx4 v13, s[44:47], s55 offen lds
    s_add_u32 m0, s58, 18432
    s_add_u32 s55, s65, 294912
    buffer_load_dwordx4 v13, s[44:47], s55 offen lds
    s_add_u32 m0, s58, 19456
    s_add_u32 s55, s65, 303104
    buffer_load_dwordx4 v13, s[44:47], s55 offen lds
    s_add_u32 m0, s58, 20480
    s_add_u32 s55, s65, 327680
    buffer_load_dwordx4 v13, s[44:47], s55 offen lds
    s_add_u32 m0, s58, 21504
    s_add_u32 s55, s65, 335872
    buffer_load_dwordx4 v13, s[44:47], s55 offen lds
    s_add_u32 m0, s58, 22528
    s_add_u32 s55, s65, 360448
    buffer_load_dwordx4 v13, s[44:47], s55 offen lds
    s_add_u32 m0, s58, 23552
    s_add_u32 s55, s65, 368640
    buffer_load_dwordx4 v13, s[44:47], s55 offen lds
    s_add_u32 m0, s58, 24576
    s_add_u32 s55, s64, 0
    buffer_load_dwordx4 v13, s[32:35], s55 offen lds
    s_add_u32 m0, s58, 25600
    s_add_u32 s55, s64, 8192
    buffer_load_dwordx4 v13, s[32:35], s55 offen lds
    s_add_u32 m0, s58, 26624
    s_add_u32 s55, s64, 32768
    buffer_load_dwordx4 v13, s[32:35], s55 offen lds
    s_add_u32 m0, s58, 27648
    s_add_u32 s55, s64, 40960
    buffer_load_dwordx4 v13, s[32:35], s55 offen lds
    s_add_u32 m0, s58, 28672
    s_add_u32 s55, s64, 65536
    buffer_load_dwordx4 v13, s[32:35], s55 offen lds
    s_add_u32 m0, s58, 29696
    s_add_u32 s55, s64, 73728
    buffer_load_dwordx4 v13, s[32:35], s55 offen lds
    s_add_u32 m0, s58, 30720
    s_add_u32 s55, s64, 98304
    buffer_load_dwordx4 v13, s[32:35], s55 offen lds
    s_add_u32 m0, s58, 31744
    s_add_u32 s55, s64, 106496
    buffer_load_dwordx4 v13, s[32:35], s55 offen lds
    s_waitcnt vmcnt(28)
    ds_read_b64_tr_b16 v[160:161], v14 offset:0
    ds_read_b64_tr_b16 v[162:163], v14 offset:256
    ds_read_b64_tr_b16 v[164:165], v14 offset:2048
    ds_read_b64_tr_b16 v[166:167], v14 offset:2304
    ds_read_b64_tr_b16 v[168:169], v15 offset:0
    ds_read_b64_tr_b16 v[170:171], v15 offset:256
    ds_read_b64_tr_b16 v[172:173], v15 offset:2048
    ds_read_b64_tr_b16 v[174:175], v15 offset:2304
    s_waitcnt lgkmcnt(0)
    s_add_u32 m0, s58, 0
    s_add_u32 s55, s64, 131072
    buffer_load_dwordx4 v13, s[32:35], s55 offen lds
    s_add_u32 m0, s58, 1024
    s_add_u32 s55, s64, 139264
    buffer_load_dwordx4 v13, s[32:35], s55 offen lds
    s_add_u32 m0, s58, 2048
    s_add_u32 s55, s64, 163840
    buffer_load_dwordx4 v13, s[32:35], s55 offen lds
    s_add_u32 m0, s58, 3072
    s_add_u32 s55, s64, 172032
    buffer_load_dwordx4 v13, s[32:35], s55 offen lds
    s_waitcnt vmcnt(28)
    ds_read_b64_tr_b16 v[176:177], v14 offset:4096
    ds_read_b64_tr_b16 v[178:179], v14 offset:4352
    ds_read_b64_tr_b16 v[180:181], v14 offset:6144
    ds_read_b64_tr_b16 v[182:183], v14 offset:6400
    ds_read_b64_tr_b16 v[184:185], v15 offset:4096
    ds_read_b64_tr_b16 v[186:187], v15 offset:4352
    ds_read_b64_tr_b16 v[188:189], v15 offset:6144
    ds_read_b64_tr_b16 v[190:191], v15 offset:6400
    s_waitcnt lgkmcnt(0)
    s_add_u32 m0, s58, 4096
    s_add_u32 s55, s64, 196608
    buffer_load_dwordx4 v13, s[32:35], s55 offen lds
    s_add_u32 m0, s58, 5120
    s_add_u32 s55, s64, 204800
    buffer_load_dwordx4 v13, s[32:35], s55 offen lds
    s_add_u32 m0, s58, 6144
    s_add_u32 s55, s64, 229376
    buffer_load_dwordx4 v13, s[32:35], s55 offen lds
    s_add_u32 m0, s58, 7168
    s_add_u32 s55, s64, 237568
    buffer_load_dwordx4 v13, s[32:35], s55 offen lds
    s_waitcnt vmcnt(28)
    ds_read_b64_tr_b16 v[192:193], v14 offset:8192
    ds_read_b64_tr_b16 v[194:195], v14 offset:8448
    ds_read_b64_tr_b16 v[196:197], v14 offset:10240
    ds_read_b64_tr_b16 v[198:199], v14 offset:10496
    ds_read_b64_tr_b16 v[200:201], v15 offset:8192
    ds_read_b64_tr_b16 v[202:203], v15 offset:8448
    ds_read_b64_tr_b16 v[204:205], v15 offset:10240
    ds_read_b64_tr_b16 v[206:207], v15 offset:10496
    s_waitcnt lgkmcnt(0)
    s_add_u32 m0, s58, 8192
    s_add_u32 s55, s64, 262144
    buffer_load_dwordx4 v13, s[32:35], s55 offen lds
    s_add_u32 m0, s58, 9216
    s_add_u32 s55, s64, 270336
    buffer_load_dwordx4 v13, s[32:35], s55 offen lds
    s_add_u32 m0, s58, 10240
    s_add_u32 s55, s64, 294912
    buffer_load_dwordx4 v13, s[32:35], s55 offen lds
    s_add_u32 m0, s58, 11264
    s_add_u32 s55, s64, 303104
    buffer_load_dwordx4 v13, s[32:35], s55 offen lds
    s_waitcnt vmcnt(28)
    ds_read_b64_tr_b16 v[208:209], v14 offset:12288
    ds_read_b64_tr_b16 v[210:211], v14 offset:12544
    ds_read_b64_tr_b16 v[212:213], v14 offset:14336
    ds_read_b64_tr_b16 v[214:215], v14 offset:14592
    ds_read_b64_tr_b16 v[216:217], v15 offset:12288
    ds_read_b64_tr_b16 v[218:219], v15 offset:12544
    ds_read_b64_tr_b16 v[220:221], v15 offset:14336
    ds_read_b64_tr_b16 v[222:223], v15 offset:14592
    s_waitcnt lgkmcnt(0)
    s_add_u32 m0, s58, 12288
    s_add_u32 s55, s64, 327680
    buffer_load_dwordx4 v13, s[32:35], s55 offen lds
    s_add_u32 m0, s58, 13312
    s_add_u32 s55, s64, 335872
    buffer_load_dwordx4 v13, s[32:35], s55 offen lds
    s_add_u32 m0, s58, 14336
    s_add_u32 s55, s64, 360448
    buffer_load_dwordx4 v13, s[32:35], s55 offen lds
    s_add_u32 m0, s58, 15360
    s_add_u32 s55, s64, 368640
    buffer_load_dwordx4 v13, s[32:35], s55 offen lds
    s_waitcnt vmcnt(28)
    ds_read_b64_tr_b16 v[224:225], v14 offset:16384
    ds_read_b64_tr_b16 v[226:227], v14 offset:16640
    ds_read_b64_tr_b16 v[228:229], v14 offset:18432
    ds_read_b64_tr_b16 v[230:231], v14 offset:18688
    ds_read_b64_tr_b16 v[232:233], v15 offset:16384
    ds_read_b64_tr_b16 v[234:235], v15 offset:16640
    ds_read_b64_tr_b16 v[236:237], v15 offset:18432
    ds_read_b64_tr_b16 v[238:239], v15 offset:18688
    s_waitcnt lgkmcnt(0)
    s_add_u32 m0, s58, 16384
    s_add_u32 s55, s64, 393216
    buffer_load_dwordx4 v13, s[32:35], s55 offen lds
    s_add_u32 m0, s58, 17408
    s_add_u32 s55, s64, 401408
    buffer_load_dwordx4 v13, s[32:35], s55 offen lds
    s_add_u32 m0, s58, 18432
    s_add_u32 s55, s64, 425984
    buffer_load_dwordx4 v13, s[32:35], s55 offen lds
    s_add_u32 m0, s58, 19456
    s_add_u32 s55, s64, 434176
    buffer_load_dwordx4 v13, s[32:35], s55 offen lds
    s_waitcnt vmcnt(28)
    ds_read_b64_tr_b16 v[240:241], v14 offset:20480
    ds_read_b64_tr_b16 v[242:243], v14 offset:20736
    ds_read_b64_tr_b16 v[244:245], v14 offset:22528
    ds_read_b64_tr_b16 v[246:247], v14 offset:22784
    ds_read_b64_tr_b16 v[248:249], v15 offset:20480
    ds_read_b64_tr_b16 v[250:251], v15 offset:20736
    ds_read_b64_tr_b16 v[252:253], v15 offset:22528
    ds_read_b64_tr_b16 v[254:255], v15 offset:22784
    s_waitcnt lgkmcnt(0)
    s_add_u32 m0, s58, 20480
    s_add_u32 s55, s64, 458752
    buffer_load_dwordx4 v13, s[32:35], s55 offen lds
    s_add_u32 m0, s58, 21504
    s_add_u32 s55, s64, 466944
    buffer_load_dwordx4 v13, s[32:35], s55 offen lds
    s_add_u32 m0, s58, 22528
    s_add_u32 s55, s64, 491520
    buffer_load_dwordx4 v13, s[32:35], s55 offen lds
    s_add_u32 m0, s58, 23552
    s_add_u32 s55, s64, 499712
    buffer_load_dwordx4 v13, s[32:35], s55 offen lds
    s_waitcnt vmcnt(28)
    ds_read_b64_tr_b16 a[0:1], v14 offset:24576
    ds_read_b64_tr_b16 a[2:3], v14 offset:24832
    ds_read_b64_tr_b16 a[4:5], v14 offset:26624
    ds_read_b64_tr_b16 a[6:7], v14 offset:26880
    ds_read_b64_tr_b16 a[8:9], v15 offset:24576
    ds_read_b64_tr_b16 a[10:11], v15 offset:24832
    ds_read_b64_tr_b16 a[12:13], v15 offset:26624
    ds_read_b64_tr_b16 a[14:15], v15 offset:26880
    s_waitcnt lgkmcnt(0)
    s_add_u32 m0, s58, 24576
    s_add_u32 s55, s64, 524288
    buffer_load_dwordx4 v13, s[32:35], s55 offen lds
    s_add_u32 m0, s58, 25600
    s_add_u32 s55, s64, 532480
    buffer_load_dwordx4 v13, s[32:35], s55 offen lds
    s_add_u32 m0, s58, 26624
    s_add_u32 s55, s64, 557056
    buffer_load_dwordx4 v13, s[32:35], s55 offen lds
    s_add_u32 m0, s58, 27648
    s_add_u32 s55, s64, 565248
    buffer_load_dwordx4 v13, s[32:35], s55 offen lds
    s_waitcnt vmcnt(28)
    ds_read_b64_tr_b16 a[16:17], v14 offset:28672
    ds_read_b64_tr_b16 a[18:19], v14 offset:28928
    ds_read_b64_tr_b16 a[20:21], v14 offset:30720
    ds_read_b64_tr_b16 a[22:23], v14 offset:30976
    ds_read_b64_tr_b16 a[24:25], v15 offset:28672
    ds_read_b64_tr_b16 a[26:27], v15 offset:28928
    ds_read_b64_tr_b16 a[28:29], v15 offset:30720
    ds_read_b64_tr_b16 a[30:31], v15 offset:30976
    s_waitcnt lgkmcnt(0)
    s_add_u32 m0, s58, 28672
    s_add_u32 s55, s64, 589824
    buffer_load_dwordx4 v13, s[32:35], s55 offen lds
    s_add_u32 m0, s58, 29696
    s_add_u32 s55, s64, 598016
    buffer_load_dwordx4 v13, s[32:35], s55 offen lds
    s_add_u32 m0, s58, 30720
    s_add_u32 s55, s64, 622592
    buffer_load_dwordx4 v13, s[32:35], s55 offen lds
    s_add_u32 m0, s58, 31744
    s_add_u32 s55, s64, 630784
    buffer_load_dwordx4 v13, s[32:35], s55 offen lds
    s_waitcnt vmcnt(28)
    ds_read_b64_tr_b16 a[32:33], v14 offset:0
    ds_read_b64_tr_b16 a[34:35], v14 offset:256
    ds_read_b64_tr_b16 a[36:37], v14 offset:2048
    ds_read_b64_tr_b16 a[38:39], v14 offset:2304
    ds_read_b64_tr_b16 a[40:41], v15 offset:0
    ds_read_b64_tr_b16 a[42:43], v15 offset:256
    ds_read_b64_tr_b16 a[44:45], v15 offset:2048
    ds_read_b64_tr_b16 a[46:47], v15 offset:2304
    s_waitcnt lgkmcnt(0)
    s_add_u32 m0, s58, 0
    s_add_u32 s55, s64, 655360
    buffer_load_dwordx4 v13, s[32:35], s55 offen lds
    s_add_u32 m0, s58, 1024
    s_add_u32 s55, s64, 663552
    buffer_load_dwordx4 v13, s[32:35], s55 offen lds
    s_add_u32 m0, s58, 2048
    s_add_u32 s55, s64, 688128
    buffer_load_dwordx4 v13, s[32:35], s55 offen lds
    s_add_u32 m0, s58, 3072
    s_add_u32 s55, s64, 696320
    buffer_load_dwordx4 v13, s[32:35], s55 offen lds
    s_waitcnt vmcnt(28)
    ds_read_b64_tr_b16 a[48:49], v14 offset:4096
    ds_read_b64_tr_b16 a[50:51], v14 offset:4352
    ds_read_b64_tr_b16 a[52:53], v14 offset:6144
    ds_read_b64_tr_b16 a[54:55], v14 offset:6400
    ds_read_b64_tr_b16 a[56:57], v15 offset:4096
    ds_read_b64_tr_b16 a[58:59], v15 offset:4352
    ds_read_b64_tr_b16 a[60:61], v15 offset:6144
    ds_read_b64_tr_b16 a[62:63], v15 offset:6400
    s_waitcnt lgkmcnt(0)
    s_add_u32 m0, s58, 4096
    s_add_u32 s55, s64, 720896
    buffer_load_dwordx4 v13, s[32:35], s55 offen lds
    s_add_u32 m0, s58, 5120
    s_add_u32 s55, s64, 729088
    buffer_load_dwordx4 v13, s[32:35], s55 offen lds
    s_add_u32 m0, s58, 6144
    s_add_u32 s55, s64, 753664
    buffer_load_dwordx4 v13, s[32:35], s55 offen lds
    s_add_u32 m0, s58, 7168
    s_add_u32 s55, s64, 761856
    buffer_load_dwordx4 v13, s[32:35], s55 offen lds
    s_waitcnt vmcnt(28)
    ds_read_b64_tr_b16 a[64:65], v14 offset:8192
    ds_read_b64_tr_b16 a[66:67], v14 offset:8448
    ds_read_b64_tr_b16 a[68:69], v14 offset:10240
    ds_read_b64_tr_b16 a[70:71], v14 offset:10496
    ds_read_b64_tr_b16 a[72:73], v15 offset:8192
    ds_read_b64_tr_b16 a[74:75], v15 offset:8448
    ds_read_b64_tr_b16 a[76:77], v15 offset:10240
    ds_read_b64_tr_b16 a[78:79], v15 offset:10496
    s_waitcnt lgkmcnt(0)
    s_add_u32 m0, s58, 8192
    s_add_u32 s55, s64, 786432
    buffer_load_dwordx4 v13, s[32:35], s55 offen lds
    s_add_u32 m0, s58, 9216
    s_add_u32 s55, s64, 794624
    buffer_load_dwordx4 v13, s[32:35], s55 offen lds
    s_add_u32 m0, s58, 10240
    s_add_u32 s55, s64, 819200
    buffer_load_dwordx4 v13, s[32:35], s55 offen lds
    s_add_u32 m0, s58, 11264
    s_add_u32 s55, s64, 827392
    buffer_load_dwordx4 v13, s[32:35], s55 offen lds
    s_waitcnt vmcnt(28)
    ds_read_b64_tr_b16 a[80:81], v14 offset:12288
    ds_read_b64_tr_b16 a[82:83], v14 offset:12544
    ds_read_b64_tr_b16 a[84:85], v14 offset:14336
    ds_read_b64_tr_b16 a[86:87], v14 offset:14592
    ds_read_b64_tr_b16 a[88:89], v15 offset:12288
    ds_read_b64_tr_b16 a[90:91], v15 offset:12544
    ds_read_b64_tr_b16 a[92:93], v15 offset:14336
    ds_read_b64_tr_b16 a[94:95], v15 offset:14592
    s_waitcnt lgkmcnt(0)
    s_add_u32 m0, s58, 12288
    s_add_u32 s55, s64, 851968
    buffer_load_dwordx4 v13, s[32:35], s55 offen lds
    s_add_u32 m0, s58, 13312
    s_add_u32 s55, s64, 860160
    buffer_load_dwordx4 v13, s[32:35], s55 offen lds
    s_add_u32 m0, s58, 14336
    s_add_u32 s55, s64, 884736
    buffer_load_dwordx4 v13, s[32:35], s55 offen lds
    s_add_u32 m0, s58, 15360
    s_add_u32 s55, s64, 892928
    buffer_load_dwordx4 v13, s[32:35], s55 offen lds
    s_waitcnt vmcnt(28)
    ds_read_b64_tr_b16 a[96:97], v14 offset:16384
    ds_read_b64_tr_b16 a[98:99], v14 offset:16640
    ds_read_b64_tr_b16 a[100:101], v14 offset:18432
    ds_read_b64_tr_b16 a[102:103], v14 offset:18688
    ds_read_b64_tr_b16 a[104:105], v15 offset:16384
    ds_read_b64_tr_b16 a[106:107], v15 offset:16640
    ds_read_b64_tr_b16 a[108:109], v15 offset:18432
    ds_read_b64_tr_b16 a[110:111], v15 offset:18688
    s_waitcnt lgkmcnt(0)
    s_add_u32 m0, s58, 16384
    s_add_u32 s55, s64, 917504
    buffer_load_dwordx4 v13, s[32:35], s55 offen lds
    s_add_u32 m0, s58, 17408
    s_add_u32 s55, s64, 925696
    buffer_load_dwordx4 v13, s[32:35], s55 offen lds
    s_add_u32 m0, s58, 18432
    s_add_u32 s55, s64, 950272
    buffer_load_dwordx4 v13, s[32:35], s55 offen lds
    s_add_u32 m0, s58, 19456
    s_add_u32 s55, s64, 958464
    buffer_load_dwordx4 v13, s[32:35], s55 offen lds
    s_waitcnt vmcnt(28)
    ds_read_b64_tr_b16 a[112:113], v14 offset:20480
    ds_read_b64_tr_b16 a[114:115], v14 offset:20736
    ds_read_b64_tr_b16 a[116:117], v14 offset:22528
    ds_read_b64_tr_b16 a[118:119], v14 offset:22784
    ds_read_b64_tr_b16 a[120:121], v15 offset:20480
    ds_read_b64_tr_b16 a[122:123], v15 offset:20736
    ds_read_b64_tr_b16 a[124:125], v15 offset:22528
    ds_read_b64_tr_b16 a[126:127], v15 offset:22784
    s_waitcnt lgkmcnt(0)
    s_add_u32 m0, s58, 20480
    s_add_u32 s55, s64, 983040
    buffer_load_dwordx4 v13, s[32:35], s55 offen lds
    s_add_u32 m0, s58, 21504
    s_add_u32 s55, s64, 991232
    buffer_load_dwordx4 v13, s[32:35], s55 offen lds
    s_add_u32 m0, s58, 22528
    s_add_u32 s55, s64, 1015808
    buffer_load_dwordx4 v13, s[32:35], s55 offen lds
    s_add_u32 m0, s58, 23552
    s_add_u32 s55, s64, 1024000
    buffer_load_dwordx4 v13, s[32:35], s55 offen lds
    s_waitcnt vmcnt(28)
    ds_read_b64_tr_b16 a[128:129], v14 offset:24576
    ds_read_b64_tr_b16 a[130:131], v14 offset:24832
    ds_read_b64_tr_b16 a[132:133], v14 offset:26624
    ds_read_b64_tr_b16 a[134:135], v14 offset:26880
    ds_read_b64_tr_b16 a[136:137], v15 offset:24576
    ds_read_b64_tr_b16 a[138:139], v15 offset:24832
    ds_read_b64_tr_b16 a[140:141], v15 offset:26624
    ds_read_b64_tr_b16 a[142:143], v15 offset:26880
    s_waitcnt lgkmcnt(0)
    s_waitcnt vmcnt(24)
    ds_read_b64_tr_b16 a[144:145], v14 offset:28672
    ds_read_b64_tr_b16 a[146:147], v14 offset:28928
    ds_read_b64_tr_b16 a[148:149], v14 offset:30720
    ds_read_b64_tr_b16 a[150:151], v14 offset:30976
    ds_read_b64_tr_b16 a[152:153], v15 offset:28672
    ds_read_b64_tr_b16 a[154:155], v15 offset:28928
    ds_read_b64_tr_b16 a[156:157], v15 offset:30720
    ds_read_b64_tr_b16 a[158:159], v15 offset:30976
    s_waitcnt lgkmcnt(0)
    s_waitcnt vmcnt(20)
    ds_read_b64_tr_b16 a[160:161], v14 offset:0
    ds_read_b64_tr_b16 a[162:163], v14 offset:256
    ds_read_b64_tr_b16 a[164:165], v14 offset:2048
    ds_read_b64_tr_b16 a[166:167], v14 offset:2304
    ds_read_b64_tr_b16 a[168:169], v15 offset:0
    ds_read_b64_tr_b16 a[170:171], v15 offset:256
    ds_read_b64_tr_b16 a[172:173], v15 offset:2048
    ds_read_b64_tr_b16 a[174:175], v15 offset:2304
    s_waitcnt lgkmcnt(0)
    s_waitcnt vmcnt(16)
    ds_read_b64_tr_b16 a[176:177], v14 offset:4096
    ds_read_b64_tr_b16 a[178:179], v14 offset:4352
    ds_read_b64_tr_b16 a[180:181], v14 offset:6144
    ds_read_b64_tr_b16 a[182:183], v14 offset:6400
    ds_read_b64_tr_b16 a[184:185], v15 offset:4096
    ds_read_b64_tr_b16 a[186:187], v15 offset:4352
    ds_read_b64_tr_b16 a[188:189], v15 offset:6144
    ds_read_b64_tr_b16 a[190:191], v15 offset:6400
    s_waitcnt lgkmcnt(0)
    s_waitcnt vmcnt(12)
    ds_read_b64_tr_b16 a[192:193], v14 offset:8192
    ds_read_b64_tr_b16 a[194:195], v14 offset:8448
    ds_read_b64_tr_b16 a[196:197], v14 offset:10240
    ds_read_b64_tr_b16 a[198:199], v14 offset:10496
    ds_read_b64_tr_b16 a[200:201], v15 offset:8192
    ds_read_b64_tr_b16 a[202:203], v15 offset:8448
    ds_read_b64_tr_b16 a[204:205], v15 offset:10240
    ds_read_b64_tr_b16 a[206:207], v15 offset:10496
    s_waitcnt lgkmcnt(0)
    s_waitcnt vmcnt(8)
    ds_read_b64_tr_b16 a[208:209], v14 offset:12288
    ds_read_b64_tr_b16 a[210:211], v14 offset:12544
    ds_read_b64_tr_b16 a[212:213], v14 offset:14336
    ds_read_b64_tr_b16 a[214:215], v14 offset:14592
    ds_read_b64_tr_b16 a[216:217], v15 offset:12288
    ds_read_b64_tr_b16 a[218:219], v15 offset:12544
    ds_read_b64_tr_b16 a[220:221], v15 offset:14336
    ds_read_b64_tr_b16 a[222:223], v15 offset:14592
    s_waitcnt lgkmcnt(0)
    s_waitcnt vmcnt(4)
    ds_read_b64_tr_b16 a[224:225], v14 offset:16384
    ds_read_b64_tr_b16 a[226:227], v14 offset:16640
    ds_read_b64_tr_b16 a[228:229], v14 offset:18432
    ds_read_b64_tr_b16 a[230:231], v14 offset:18688
    ds_read_b64_tr_b16 a[232:233], v15 offset:16384
    ds_read_b64_tr_b16 a[234:235], v15 offset:16640
    ds_read_b64_tr_b16 a[236:237], v15 offset:18432
    ds_read_b64_tr_b16 a[238:239], v15 offset:18688
    s_waitcnt lgkmcnt(0)
    s_waitcnt vmcnt(0)
    ds_read_b64_tr_b16 a[240:241], v14 offset:20480
    ds_read_b64_tr_b16 a[242:243], v14 offset:20736
    ds_read_b64_tr_b16 a[244:245], v14 offset:22528
    ds_read_b64_tr_b16 a[246:247], v14 offset:22784
    ds_read_b64_tr_b16 a[248:249], v15 offset:20480
    ds_read_b64_tr_b16 a[250:251], v15 offset:20736
    ds_read_b64_tr_b16 a[252:253], v15 offset:22528
    ds_read_b64_tr_b16 a[254:255], v15 offset:22784
    s_waitcnt lgkmcnt(0)
    v_mov_b32 v12, 0
L_wf_21:
    buffer_load_dword v11, v12, s[8:11], 0 offen offset:16 sc1
    s_waitcnt vmcnt(0)
    v_cmp_ge_u32 vcc, 0, v11
    s_cbranch_vccz L_wfd_22
    s_sub_u32 s59, s59, 1
    s_cbranch_scc1 L_timeout
    s_sleep 2
    s_branch L_wf_21
L_wfd_22:
    s_barrier
    v_and_b32 v11, 7, v8
    s_lshl_b32 s55, s52, 10
    v_lshl_add_u32 v2, v11, 7, s55
    v_bfe_u32 v11, v8, 3, 1
    v_lshl_add_u32 v2, v11, 2, v2
    v_min_u32 v11, 10, v8
    v_lshlrev_b32 v3, 2, v11
    v_lshlrev_b32 v11, 10, v10
    v_lshl_add_u32 v11, v9, 3, v11
    s_lshl_b32 s55, s62, 6
    s_and_b32 s56, s52, 1
    s_lshl_b32 s57, s56, 5
    s_add_u32 s55, s55, s57
    v_add_u32 v4, s55, v11
    s_lshl_b32 s55, s52, 12
    v_add_u32 v5, s55, v1
    s_lshl_b32 s55, s56, 10
    v_add_u32 v6, s55, v1
    s_mov_b32 s73, s61
    s_mov_b64 s[74:75], -1
    s_mov_b32 s71, 0xffff0000
    s_mov_b32 s72, 0xbfb8aa3b
L_f_loop:
    s_mov_b32 s63, s73
    s_cmp_lt_u32 s73, 999
    s_cbranch_scc1 L_f_full
    s_lshr_b32 s63, s61, 1
    s_add_u32 s63, s63, 126
    s_and_b32 s55, s61, 1
    s_lshl_b32 s55, s55, 3
    s_lshl_b32 s74, 0x00ff00ff, s55
    s_mov_b32 s75, s74
L_f_full:
    s_lshr_b32 s66, s63, 1
    s_mul_i32 s68, s63, 44032
    s_add_u32 s69, s68, 0x40a800
    s_mul_i32 s55, s52, 11264
    s_add_u32 s68, s68, s55
    s_add_u32 s68, s68, 0x400000
    s_lshl_b32 s67, s63, 17
    s_lshl_b32 s55, s52, 15
    s_add_u32 s67, s67, s55
    s_add_u32 s67, s67, 0x1000000
    s_lshl_b32 s70, s63, 14
    buffer_load_dwordx2 v[14:15], v4, s[12:15], s70 offen
    s_and_b32 s56, s66, 7
    s_lshl_b32 s56, s56, 7
    s_add_u32 s56, s56, 1024
L_wf_23:
    buffer_load_dword v11, v3, s[4:7], s56 offen offset:0 sc1
    s_waitcnt vmcnt(0)
    v_cmp_ge_u32 vcc, s66, v11
    s_cbranch_vccz L_wfd_24
    s_sub_u32 s59, s59, 1
    s_cbranch_scc1 L_timeout
    s_sleep 2
    s_branch L_wf_23
L_wfd_24:
    buffer_load_dwordx4 v[32:35], v1, s[4:7], s68 offen offset:0 sc1
    buffer_load_dwordx4 v[36:39], v1, s[4:7], s68 offen offset:1024 sc1
    buffer_load_dwordx4 v[40:43], v1, s[4:7], s68 offen offset:2048 sc1
    buffer_load_dwordx4 v[44:47], v1, s[4:7], s68 offen offset:3072 sc1
    s_add_u32 s68, s68, 4096
    buffer_load_dwordx4 v[48:51], v1, s[4:7], s68 offen offset:0 sc1
    buffer_load_dwordx4 v[52:55], v1, s[4:7], s68 offen offset:1024 sc1
    buffer_load_dwordx4 v[56:59], v1, s[4:7], s68 offen offset:2048 sc1
    buffer_load_dwordx4 v[60:63], v1, s[4:7], s68 offen offset:3072 sc1
    s_add_u32 s68, s68, 4096
    buffer_load_dwordx4 v[64:67], v1, s[4:7], s68 offen offset:0 sc1
    buffer_load_dwordx4 v[68:71], v1, s[4:7], s68 offen offset:1024 sc1
    s_add_u32 s68, s68, 2048
    s_min_u32 s68, s68, s69
    buffer_load_dwordx4 v[72:75], v1, s[4:7], s68 offen sc1
    s_waitcnt vmcnt(10)
    v_mfma_f32_16x16x32_bf16 v[24:27], v[160:163], v[32:35], 0
    v_mfma_f32_16x16x32_bf16 v[28:31], v[168:171], v[32:35], 0
    s_waitcnt vmcnt(9)
    v_mfma_f32_16x16x32_bf16 v[24:27], v[164:167], v[36:39], v[24:27]
    v_mfma_f32_16x16x32_bf16 v[28:31], v[172:175], v[36:39], v[28:31]
    s_waitcnt vmcnt(8)
    v_mfma_f32_16x16x32_bf16 v[24:27], v[176:179], v[40:43], v[24:27]
    v_mfma_f32_16x16x32_bf16 v[28:31], v[184:187], v[40:43], v[28:31]
    s_waitcnt vmcnt(7)
    v_mfma_f32_16x16x32_bf16 v[24:27], v[180:183], v[44:47], v[24:27]
    v_mfma_f32_16x16x32_bf16 v[28:31], v[188:191], v[44:47], v[28:31]
    s_waitcnt vmcnt(6)
    v_mfma_f32_16x16x32_bf16 v[24:27], v[192:195], v[48:51], v[24:27]
    v_mfma_f32_16x16x32_bf16 v[28:31], v[200:203], v[48:51], v[28:31]
    s_waitcnt vmcnt(5)
    v_mfma_f32_16x16x32_bf16 v[24:27], v[196:199], v[52:55], v[24:27]
    v_mfma_f32_16x16x32_bf16 v[28:31], v[204:207], v[52:55], v[28:31]
    s_waitcnt vmcnt(4)
    v_mfma_f32_16x16x32_bf16 v[24:27], v[208:211], v[56:59], v[24:27]
    v_mfma_f32_16x16x32_bf16 v[28:31], v[216:219], v[56:59], v[28:31]
    s_waitcnt vmcnt(3)
    v_mfma_f32_16x16x32_bf16 v[24:27], v[212:215], v[60:63], v[24:27]
    v_mfma_f32_16x16x32_bf16 v[28:31], v[220:223], v[60:63], v[28:31]
    s_waitcnt vmcnt(2)
    v_mfma_f32_16x16x32_bf16 v[24:27], v[224:227], v[64:67], v[24:27]
    v_mfma_f32_16x16x32_bf16 v[28:31], v[232:235], v[64:67], v[28:31]
    s_waitcnt vmcnt(1)
    v_mfma_f32_16x16x32_bf16 v[24:27], v[228:231], v[68:71], v[24:27]
    v_mfma_f32_16x16x32_bf16 v[28:31], v[236:239], v[68:71], v[28:31]
    s_waitcnt vmcnt(0)
    v_mfma_f32_16x16x32_bf16 v[24:27], v[240:243], v[72:75], v[24:27]
    v_mfma_f32_16x16x32_bf16 v[28:31], v[248:251], v[72:75], v[28:31]
    s_mul_hi_u32 s55, s66, 0x55555556
    s_mul_i32 s55, s55, 3
    s_sub_u32 s56, s66, s55
    s_lshl_b32 s56, s56, 12
    s_and_b32 s55, s63, 1
    s_lshl_b32 s55, s55, 3
    s_add_u32 s56, s56, s55
    s_lshl_b32 s55, s52, 6
    s_add_u32 s56, s56, 8192
L_wf_25:
    buffer_load_dword v11, v2, s[4:7], s56 offen offset:0 sc1
    s_waitcnt vmcnt(0)
    v_cmp_ge_u32 vcc, s66, v11
    s_cbranch_vccz L_wfd_26
    s_sub_u32 s59, s59, 1
    s_cbranch_scc1 L_timeout
    s_sleep 2
    s_branch L_wf_25
L_wfd_26:
    s_mov_b64 exec, s[74:75]
    buffer_load_dwordx4 v[32:35], v1, s[4:7], s67 offen offset:0 sc1
    buffer_load_dwordx4 v[36:39], v1, s[4:7], s67 offen offset:1024 sc1
    buffer_load_dwordx4 v[40:43], v1, s[4:7], s67 offen offset:2048 sc1
    buffer_load_dwordx4 v[44:47], v1, s[4:7], s67 offen offset:3072 sc1
    s_add_u32 s67, s67, 4096
    buffer_load_dwordx4 v[48:51], v1, s[4:7], s67 offen offset:0 sc1
    buffer_load_dwordx4 v[52:55], v1, s[4:7], s67 offen offset:1024 sc1
    buffer_load_dwordx4 v[56:59], v1, s[4:7], s67 offen offset:2048 sc1
    buffer_load_dwordx4 v[60:63], v1, s[4:7], s67 offen offset:3072 sc1
    s_add_u32 s67, s67, 4096
    buffer_load_dwordx4 v[64:67], v1, s[4:7], s67 offen offset:0 sc1
    buffer_load_dwordx4 v[68:71], v1, s[4:7], s67 offen offset:1024 sc1
    buffer_load_dwordx4 v[72:75], v1, s[4:7], s67 offen offset:2048 sc1
    buffer_load_dwordx4 v[76:79], v1, s[4:7], s67 offen offset:3072 sc1
    s_add_u32 s67, s67, 4096
    buffer_load_dwordx4 v[80:83], v1, s[4:7], s67 offen offset:0 sc1
    buffer_load_dwordx4 v[84:87], v1, s[4:7], s67 offen offset:1024 sc1
    buffer_load_dwordx4 v[88:91], v1, s[4:7], s67 offen offset:2048 sc1
    buffer_load_dwordx4 v[92:95], v1, s[4:7], s67 offen offset:3072 sc1
    s_add_u32 s67, s67, 4096
    buffer_load_dwordx4 v[96:99], v1, s[4:7], s67 offen offset:0 sc1
    buffer_load_dwordx4 v[100:103], v1, s[4:7], s67 offen offset:1024 sc1
    buffer_load_dwordx4 v[104:107], v1, s[4:7], s67 offen offset:2048 sc1
    buffer_load_dwordx4 v[108:111], v1, s[4:7], s67 offen offset:3072 sc1
    s_add_u32 s67, s67, 4096
    buffer_load_dwordx4 v[112:115], v1, s[4:7], s67 offen offset:0 sc1
    buffer_load_dwordx4 v[116:119], v1, s[4:7], s67 offen offset:1024 sc1
    buffer_load_dwordx4 v[120:123], v1, s[4:7], s67 offen offset:2048 sc1
    buffer_load_dwordx4 v[124:127], v1, s[4:7], s67 offen offset:3072 sc1
    s_add_u32 s67, s67, 4096
    buffer_load_dwordx4 v[128:131], v1, s[4:7], s67 offen offset:0 sc1
    buffer_load_dwordx4 v[132:135], v1, s[4:7], s67 offen offset:1024 sc1
    buffer_load_dwordx4 v[136:139], v1, s[4:7], s67 offen offset:2048 sc1
    buffer_load_dwordx4 v[140:143], v1, s[4:7], s67 offen offset:3072 sc1
    s_add_u32 s67, s67, 4096
    buffer_load_dwordx4 v[144:147], v1, s[4:7], s67 offen offset:0 sc1
    buffer_load_dwordx4 v[148:151], v1, s[4:7], s67 offen offset:1024 sc1
    buffer_load_dwordx4 v[152:155], v1, s[4:7], s67 offen offset:2048 sc1
    buffer_load_dwordx4 v[156:159], v1, s[4:7], s67 offen offset:3072 sc1
    s_add_u32 s67, s67, 4096
    s_mov_b64 exec, -1
    s_waitcnt vmcnt(31)
    v_mfma_f32_16x16x32_bf16 v[16:19], a[0:3], v[32:35], 0
    v_mfma_f32_16x16x32_bf16 v[20:23], a[8:11], v[32:35], 0
    s_waitcnt vmcnt(30)
    v_mfma_f32_16x16x32_bf16 v[16:19], a[4:7], v[36:39], v[16:19]
    v_mfma_f32_16x16x32_bf16 v[20:23], a[12:15], v[36:39], v[20:23]
    s_waitcnt vmcnt(29)
    v_mfma_f32_16x16x32_bf16 v[16:19], a[16:19], v[40:43], v[16:19]
    v_mfma_f32_16x16x32_bf16 v[20:23], a[24:27], v[40:43], v[20:23]
    s_waitcnt vmcnt(28)
    v_mfma_f32_16x16x32_bf16 v[16:19], a[20:23], v[44:47], v[16:19]
    v_mfma_f32_16x16x32_bf16 v[20:23], a[28:31], v[44:47], v[20:23]
    s_waitcnt vmcnt(27)
    v_mfma_f32_16x16x32_bf16 v[16:19], a[32:35], v[48:51], v[16:19]
    v_mfma_f32_16x16x32_bf16 v[20:23], a[40:43], v[48:51], v[20:23]
    s_waitcnt vmcnt(26)
    v_mfma_f32_16x16x32_bf16 v[16:19], a[36:39], v[52:55], v[16:19]
    v_mfma_f32_16x16x32_bf16 v[20:23], a[44:47], v[52:55], v[20:23]
    s_waitcnt vmcnt(25)
    v_mfma_f32_16x16x32_bf16 v[16:19], a[48:51], v[56:59], v[16:19]
    v_mfma_f32_16x16x32_bf16 v[20:23], a[56:59], v[56:59], v[20:23]
    s_waitcnt vmcnt(24)
    v_mfma_f32_16x16x32_bf16 v[16:19], a[52:55], v[60:63], v[16:19]
    v_mfma_f32_16x16x32_bf16 v[20:23], a[60:63], v[60:63], v[20:23]
    s_waitcnt vmcnt(23)
    v_mfma_f32_16x16x32_bf16 v[16:19], a[64:67], v[64:67], v[16:19]
    v_mfma_f32_16x16x32_bf16 v[20:23], a[72:75], v[64:67], v[20:23]
    s_waitcnt vmcnt(22)
    v_mfma_f32_16x16x32_bf16 v[16:19], a[68:71], v[68:71], v[16:19]
    v_mfma_f32_16x16x32_bf16 v[20:23], a[76:79], v[68:71], v[20:23]
    s_waitcnt vmcnt(21)
    v_mfma_f32_16x16x32_bf16 v[16:19], a[80:83], v[72:75], v[16:19]
    v_mfma_f32_16x16x32_bf16 v[20:23], a[88:91], v[72:75], v[20:23]
    s_waitcnt vmcnt(20)
    v_mfma_f32_16x16x32_bf16 v[16:19], a[84:87], v[76:79], v[16:19]
    v_mfma_f32_16x16x32_bf16 v[20:23], a[92:95], v[76:79], v[20:23]
    s_waitcnt vmcnt(19)
    v_mfma_f32_16x16x32_bf16 v[16:19], a[96:99], v[80:83], v[16:19]
    v_mfma_f32_16x16x32_bf16 v[20:23], a[104:107], v[80:83], v[20:23]
    s_waitcnt vmcnt(18)
    v_mfma_f32_16x16x32_bf16 v[16:19], a[100:103], v[84:87], v[16:19]
    v_mfma_f32_16x16x32_bf16 v[20:23], a[108:111], v[84:87], v[20:23]
    s_waitcnt vmcnt(17)
    v_mfma_f32_16x16x32_bf16 v[16:19], a[112:115], v[88:91], v[16:19]
    v_mfma_f32_16x16x32_bf16 v[20:23], a[120:123], v[88:91], v[20:23]
    s_waitcnt vmcnt(16)
    v_mfma_f32_16x16x32_bf16 v[16:19], a[116:119], v[92:95], v[16:19]
    v_mfma_f32_16x16x32_bf16 v[20:23], a[124:127], v[92:95], v[20:23]
    s_waitcnt vmcnt(15)
    v_mfma_f32_16x16x32_bf16 v[16:19], a[128:131], v[96:99], v[16:19]
    v_mfma_f32_16x16x32_bf16 v[20:23], a[136:139], v[96:99], v[20:23]
    s_waitcnt vmcnt(14)
    v_mfma_f32_16x16x32_bf16 v[16:19], a[132:135], v[100:103], v[16:19]
    v_mfma_f32_16x16x32_bf16 v[20:23], a[140:143], v[100:103], v[20:23]
    s_waitcnt vmcnt(13)
    v_mfma_f32_16x16x32_bf16 v[16:19], a[144:147], v[104:107], v[16:19]
    v_mfma_f32_16x16x32_bf16 v[20:23], a[152:155], v[104:107], v[20:23]
    s_waitcnt vmcnt(12)
    v_mfma_f32_16x16x32_bf16 v[16:19], a[148:151], v[108:111], v[16:19]
    v_mfma_f32_16x16x32_bf16 v[20:23], a[156:159], v[108:111], v[20:23]
    s_waitcnt vmcnt(11)
    v_mfma_f32_16x16x32_bf16 v[16:19], a[160:163], v[112:115], v[16:19]
    v_mfma_f32_16x16x32_bf16 v[20:23], a[168:171], v[112:115], v[20:23]
    s_waitcnt vmcnt(10)
    v_mfma_f32_16x16x32_bf16 v[16:19], a[164:167], v[116:119], v[16:19]
    v_mfma_f32_16x16x32_bf16 v[20:23], a[172:175], v[116:119], v[20:23]
    s_waitcnt vmcnt(9)
    v_mfma_f32_16x16x32_bf16 v[16:19], a[176:179], v[120:123], v[16:19]
    v_mfma_f32_16x16x32_bf16 v[20:23], a[184:187], v[120:123], v[20:23]
    s_waitcnt vmcnt(8)
    v_mfma_f32_16x16x32_bf16 v[16:19], a[180:183], v[124:127], v[16:19]
    v_mfma_f32_16x16x32_bf16 v[20:23], a[188:191], v[124:127], v[20:23]
    s_waitcnt vmcnt(7)
    v_mfma_f32_16x16x32_bf16 v[16:19], a[192:195], v[128:131], v[16:19]
    v_mfma_f32_16x16x32_bf16 v[20:23], a[200:203], v[128:131], v[20:23]
    s_waitcnt vmcnt(6)
    v_mfma_f32_16x16x32_bf16 v[16:19], a[196:199], v[132:135], v[16:19]
    v_mfma_f32_16x16x32_bf16 v[20:23], a[204:207], v[132:135], v[20:23]
    s_waitcnt vmcnt(5)
    v_mfma_f32_16x16x32_bf16 v[16:19], a[208:211], v[136:139], v[16:19]
    v_mfma_f32_16x16x32_bf16 v[20:23], a[216:219], v[136:139], v[20:23]
    s_waitcnt vmcnt(4)
    v_mfma_f32_16x16x32_bf16 v[16:19], a[212:215], v[140:143], v[16:19]
    v_mfma_f32_16x16x32_bf16 v[20:23], a[220:223], v[140:143], v[20:23]
    s_waitcnt vmcnt(3)
    v_mfma_f32_16x16x32_bf16 v[16:19], a[224:227], v[144:147], v[16:19]
    v_mfma_f32_16x16x32_bf16 v[20:23], a[232:235], v[144:147], v[20:23]
    s_waitcnt vmcnt(2)
    v_mfma_f32_16x16x32_bf16 v[16:19], a[228:231], v[148:151], v[16:19]
    v_mfma_f32_16x16x32_bf16 v[20:23], a[236:239], v[148:151], v[20:23]
    s_waitcnt vmcnt(1)
    v_mfma_f32_16x16x32_bf16 v[16:19], a[240:243], v[152:155], v[16:19]
    v_mfma_f32_16x16x32_bf16 v[20:23], a[248:251], v[152:155], v[20:23]
    s_waitcnt vmcnt(0)
    v_mfma_f32_16x16x32_bf16 v[16:19], a[244:247], v[156:159], v[16:19]
    v_mfma_f32_16x16x32_bf16 v[20:23], a[252:255], v[156:159], v[20:23]
    ds_write_b128 v5, v[24:27] offset:2048
    ds_write_b128 v5, v[28:31] offset:3072
    s_nop 1
    ds_write_b128 v5, v[16:19] offset:0
    s_nop 2
    ds_write_b128 v5, v[20:23] offset:1024
    v_xor_b32 v5, 0x4000, v5
    s_add_u32 s73, s73, 6
    s_waitcnt lgkmcnt(0)
    s_barrier
    s_cmp_ge_u32 s52, 2
    s_cbranch_scc1 L_f_next
    ds_read_b128 v[32:35], v6 offset:2048
    ds_read_b128 v[36:39], v6 offset:6144
    ds_read_b128 v[40:43], v6 offset:10240
    ds_read_b128 v[44:47], v6 offset:14336
    ds_read_b128 v[48:51], v6 offset:0
    ds_read_b128 v[52:55], v6 offset:4096
    ds_read_b128 v[56:59], v6 offset:8192
    ds_read_b128 v[60:63], v6 offset:12288
    s_waitcnt lgkmcnt(4)
    v_pk_add_f32 v[32:33], v[32:33], v[36:37]
    v_pk_add_f32 v[40:41], v[40:41], v[44:45]
    v_pk_add_f32 v[34:35], v[34:35], v[38:39]
    v_pk_add_f32 v[42:43], v[42:43], v[46:47]
    v_pk_add_f32 v[32:33], v[32:33], v[40:41]
    v_pk_add_f32 v[34:35], v[34:35], v[42:43]
    v_cvt_pk_bf16_f32 v33, v32, v33
    v_lshlrev_b32 v32, 16, v33
    v_and_b32 v33, s71, v33
    v_cvt_pk_bf16_f32 v35, v34, v35
    v_lshlrev_b32 v34, 16, v35
    v_and_b32 v35, s71, v35
    v_mul_f32 v36, s72, v32
    v_mul_f32 v37, s72, v33
    v_mul_f32 v38, s72, v34
    v_mul_f32 v39, s72, v35
    v_exp_f32 v36, v36
    v_exp_f32 v37, v37
    v_exp_f32 v38, v38
    v_exp_f32 v39, v39
    v_add_f32 v36, 1.0, v36
    v_add_f32 v37, 1.0, v37
    v_add_f32 v38, 1.0, v38
    v_add_f32 v39, 1.0, v39
    v_rcp_f32 v36, v36
    v_rcp_f32 v37, v37
    v_rcp_f32 v38, v38
    v_rcp_f32 v39, v39
    v_mul_f32 v32, v32, v36
    v_mul_f32 v33, v33, v37
    v_mul_f32 v34, v34, v38
    v_mul_f32 v35, v35, v39
    v_cvt_pk_bf16_f32 v33, v32, v33
    v_lshlrev_b32 v32, 16, v33
    v_and_b32 v33, s71, v33
    v_cvt_pk_bf16_f32 v35, v34, v35
    v_lshlrev_b32 v34, 16, v35
    v_and_b32 v35, s71, v35
    s_waitcnt lgkmcnt(0)
    v_pk_add_f32 v[48:49], v[48:49], v[52:53]
    v_pk_add_f32 v[56:57], v[56:57], v[60:61]
    v_pk_add_f32 v[50:51], v[50:51], v[54:55]
    v_pk_add_f32 v[58:59], v[58:59], v[62:63]
    v_pk_add_f32 v[48:49], v[48:49], v[56:57]
    v_pk_add_f32 v[50:51], v[50:51], v[58:59]
    v_cvt_pk_bf16_f32 v49, v48, v49
    v_lshlrev_b32 v48, 16, v49
    v_and_b32 v49, s71, v49
    v_cvt_pk_bf16_f32 v51, v50, v51
    v_lshlrev_b32 v50, 16, v51
    v_and_b32 v51, s71, v51
    v_mul_f32 v48, v48, v32
    v_mul_f32 v49, v49, v33
    v_mul_f32 v50, v50, v34
    v_mul_f32 v51, v51, v35
    v_cvt_pk_bf16_f32 v49, v48, v49
    v_lshlrev_b32 v48, 16, v49
    v_and_b32 v49, s71, v49
    v_cvt_pk_bf16_f32 v51, v50, v51
    v_lshlrev_b32 v50, 16, v51
    v_and_b32 v51, s71, v51
    v_lshlrev_b32 v32, 16, v14
    v_and_b32 v33, s71, v14
    v_lshlrev_b32 v34, 16, v15
    v_and_b32 v35, s71, v15
    v_add_f32 v48, v48, v32
    v_add_f32 v49, v49, v33
    v_add_f32 v50, v50, v34
    v_add_f32 v51, v51, v35
    v_cvt_pk_bf16_f32 v48, v48, v49
    v_cvt_pk_bf16_f32 v49, v50, v51
    s_mov_b64 exec, s[74:75]
    buffer_store_dwordx2 v[48:49], v4, s[48:51], s70 offen
    s_mov_b64 exec, -1
L_f_next:
    v_xor_b32 v6, 0x4000, v6
    s_cmp_lt_u32 s73, 128
    s_cbranch_scc1 L_f_loop
    s_branch L_end
L_timeout:
    s_mov_b64 exec, 1
    v_mov_b32 v1, 0
    v_mov_b32 v2, 1
    buffer_atomic_add v2, v1, s[8:11], 0 offen offset:20 sc1
    s_waitcnt vmcnt(0)
L_end:
    s_endpgm
.section .rodata,"a"
.p2align 6
.amdhsa_kernel recurrent_scan__memory_aug_recurrent_mem_tr__glu_gated_bilinear__prompt_kernel
  .amdhsa_next_free_vgpr 512
  .amdhsa_next_free_sgpr 102
  .amdhsa_accum_offset 256
  .amdhsa_group_segment_fixed_size 0
  .amdhsa_kernarg_size 112
  .amdhsa_user_sgpr_count 2
  .amdhsa_user_sgpr_kernarg_segment_ptr 1
  .amdhsa_system_sgpr_workgroup_id_x 1
.end_amdhsa_kernel
```
